```python
import torch

def _softmax(x, axis=-1):
    return torch.softmax(x, dim=axis)
def _gelu(x):
    return torch.nn.functional.gelu(x, approximate="tanh")
def _silu(x):
    return torch.nn.functional.silu(x)
def _sigmoid(x):
    return torch.sigmoid(x)
def _layernorm(x, axis=-1, eps=1e-5):
    m = x.mean(dim=axis, keepdim=True)
    v = x.var(dim=axis, keepdim=True, unbiased=False)
    return (x - m) / torch.sqrt(v + eps)
def _scatter_add(tgt, idx, src, axis=0):
    return tgt.clone().index_add_(axis, idx, src)
def _segment_sum(src, seg, n):
    out = torch.zeros((n,) + src.shape[1:], dtype=src.dtype)
    return out.index_add_(0, seg, src)
def _pad(x, pw):
    flat = tuple(v for pair in reversed(pw) for v in pair)
    return torch.nn.functional.pad(x, flat)

kernel_name = 'recurrent_scan__gqa_block_cached__mixer_channel_mlp__decode'

def setup_inputs():

    _w = (lambda a: (lambda t: t.to(torch.bfloat16) if t.is_floating_point() else t)(torch.as_tensor(a)))
    def _A_setup():
        B, Sq, D = 1, 1, 512
        Hq, Hkv, Sk, Dh = 32, 32, 8192, 128
        assert Hq % Hkv == 0, (Hq, Hkv)
        return {
            "x": _w((lambda *s: torch.randn(*s, dtype=torch.bfloat16) * 0.1)(B, Sq, D)),
            "k_cache": _w((lambda *s: torch.randn(*s, dtype=torch.bfloat16) * 0.8)(B, Hkv, Sk, Dh)),
            "v_cache": _w((lambda *s: torch.randn(*s, dtype=torch.bfloat16) * 3.2)(B, Hkv, Sk, Dh)),
            "wq": _w((lambda *s: torch.randn(*s, dtype=torch.bfloat16) * 0.8)(D, Hq * Dh) * (D ** -0.5)),
            "wo": _w((lambda *s: torch.randn(*s, dtype=torch.bfloat16) * 3.2)(Hq * Dh, D) * ((Hq * Dh) ** -0.5)),
        }
    _A_in = _A_setup()

    def _B_setup():
        B, S, D, F = 1, 1, 512, 1376
        return {
            "x": _w((lambda *s: torch.randn(*s, dtype=torch.bfloat16) * 0.1)(B, S, D)),
            "w1": _w((lambda *s: torch.randn(*s, dtype=torch.bfloat16) * 3.2)(D, F) * (D ** -0.5)),
            "b1": _w((lambda *s: torch.randn(*s, dtype=torch.bfloat16) * 3.2)(F)),
            "w2": _w((lambda *s: torch.randn(*s, dtype=torch.bfloat16) * 3.2)(F, D) * (F ** -0.5)),
            "b2": _w((lambda *s: torch.randn(*s, dtype=torch.bfloat16) * 3.2)(D)),
        }
    _B_in = _B_setup()

    return {
        "A_x": _A_in["x"],
        "A_k_cache": _A_in["k_cache"],
        "A_v_cache": _A_in["v_cache"],
        "A_wq": _A_in["wq"],
        "A_wo": _A_in["wo"],
        "B_x": _B_in["x"],
        "B_w1": _B_in["w1"],
        "B_b1": _B_in["b1"],
        "B_w2": _B_in["w2"],
        "B_b2": _B_in["b2"],
    }

def reference(A_x, A_k_cache, A_v_cache, A_wq, A_wo, B_x, B_w1, B_b1, B_w2, B_b2):
    def _A_ref(x, k_cache, v_cache, wq, wo):
        B, Sq, D = x.shape
        Hq, Dh = 32, 128
        Hkv = k_cache.shape[1]
        rep = Hq // Hkv
        q = (lambda x, *d: x.permute(*d))((x @ wq).reshape(B, Sq, Hq, Dh), 0, 2, 1, 3)
        k = (lambda x, n, axis: torch.repeat_interleave(x, n, dim=axis))(k_cache, rep, axis=1)
        v = (lambda x, n, axis: torch.repeat_interleave(x, n, dim=axis))(v_cache, rep, axis=1)
        scores = torch.einsum("bhqd,bhkd->bhqk", q, k) * (Dh ** -0.5)
        p = _softmax(scores, axis=-1)
        o = torch.einsum("bhqk,bhkd->bhqd", p, v)
        return (lambda x, *d: x.permute(*d))(o, 0, 2, 1, 3).reshape(B, Sq, Hq * Dh) @ wo

    def _B_ref(x, w1, b1, w2, b2):
        y = _layernorm(x, axis=-1)
        h = _gelu(torch.einsum("bsd,df->bsf", y, w1) + b1)
        return torch.einsum("bsf,fd->bsd", h, w2) + b2

    x = A_x
    xn = _layernorm(x, axis=-1)
    s = _A_ref(xn, A_k_cache, A_v_cache, A_wq, A_wo)
    g = _silu(_B_ref(xn, B_w1, B_b1, B_w2, B_b2))
    return x + s * g
```

```asm
; @launch grid=(256,1,1) block=(512,1,1) lds=33024
.amdgcn_target "amdgcn-amd-amdhsa--gfx950"
.text
.globl recurrent_scan__gqa_block_cached__mixer_channel_mlp__decode_kernel
.p2align 8
.type recurrent_scan__gqa_block_cached__mixer_channel_mlp__decode_kernel,@function
recurrent_scan__gqa_block_cached__mixer_channel_mlp__decode_kernel:
    s_cmp_ge_u32 s2, 256
    s_cbranch_scc1 L_end
    s_load_dwordx16 s[4:19], s[0:1], 0
    s_load_dwordx8 s[20:27], s[0:1], 64
    s_load_dwordx2 s[28:29], s[0:1], 96
    s_and_b32 s64, s2, 7
    s_lshr_b32 s65, s2, 3
    s_lshr_b32 s74, s65, 3
    s_and_b32 s67, s65, 7
    s_lshl_b32 s66, s64, 2
    s_add_u32 s66, s66, s74
    s_lshl_b32 s68, s64, 5
    s_add_u32 s68, s68, s65
    s_lshl_b32 s71, s68, 18
    v_and_b32 v1, 63, v0
    v_lshlrev_b32 v2, 4, v0
    v_lshlrev_b32 v56, 4, v1
    v_lshrrev_b32 v57, 3, v0
    v_lshrrev_b32 v58, 6, v0
    s_nop 0
    v_readfirstlane_b32 s73, v58
    s_mul_i32 s101, s64, 1
    s_and_b32 s101, s101, 31
    s_lshl_b32 s101, s101, 10
    v_lshlrev_b32 v2, 4, v1
    v_lshl_add_u32 v2, v58, 15, v2
    v_mul_u32_u24 v5, 0xac0, v57
    v_and_b32 v59, 7, v0
    v_lshl_add_u32 v5, v59, 4, v5
    s_lshl_b32 s75, s67, 7
    v_lshl_add_u32 v57, v57, 1, s75
    v_lshrrev_b32 v59, 4, v0
    v_and_b32 v60, 15, v0
    v_lshlrev_b32 v61, 14, v59
    v_lshl_add_u32 v3, v60, 4, v61
    v_and_b32 v59, 3, v59
    v_lshlrev_b32 v59, 10, v59
    v_lshl_add_u32 v59, v60, 4, v59
    v_lshl_add_u32 v4, v58, 14, v59
    v_lshlrev_b32 v6, 2, v0
    s_lshl_b32 s74, s74, 3
    s_add_u32 s74, s74, s64
    s_lshl_b32 s76, s74, 7
    s_mul_i32 s77, s67, 176128
    s_add_u32 s98, s76, s77
    s_sub_u32 s75, 0x158000, s98
    s_cmp_lt_u32 s74, 22
    s_cselect_b32 s50, s75, 0
    s_cselect_b32 s98, s98, 0
    s_lshl_b32 s69, s74, 3
    s_add_u32 s69, s69, s67
    s_cmp_lt_u32 s69, 172
    s_cselect_b32 s69, s69, 0
    s_cselect_b32 s54, 0x2000, 0
    s_mul_i32 s80, s69, 2176
    s_cselect_b32 s80, s80, 0x7fff0000
    s_mul_i32 s72, s68, 2176
    s_mov_b32 s34, 0x40000
    s_mov_b32 s38, 0x40000
    s_lshl_b32 s75, s66, 8
    s_lshl_b32 s74, s67, 19
    s_add_u32 s75, s75, s74
    s_sub_u32 s42, 0x400000, s75
    s_mov_b32 s46, 0x20000
    s_mov_b32 s58, 0x15b600
    s_mov_b32 s62, 0x5b600
    s_mov_b32 s35, 0x20000
    s_mov_b32 s39, 0x20000
    s_mov_b32 s43, 0x20000
    s_mov_b32 s47, 0x20000
    s_mov_b32 s51, 0x20000
    s_mov_b32 s55, 0x20000
    s_mov_b32 s59, 0x20000
    s_mov_b32 s63, 0x20000
    s_lshl_b32 s76, s66, 17
    s_lshl_b32 s77, s69, 13
    s_lshl_b32 s78, s69, 3
    s_add_u32 s78, s78, s73
    s_lshr_b32 s82, s78, 1
    s_lshl_b32 s82, s82, 2
    s_mov_b32 s81, 0x3e0293ee
    s_waitcnt lgkmcnt(0)
    global_load_dwordx4 v[224:227], v56, s[4:5]
    global_load_ushort v228, v57, s[4:5]
    s_add_u32 s32, s6, s71
    s_addc_u32 s33, s7, 0
    s_add_u32 s40, s10, s75
    s_addc_u32 s41, s11, 0
    s_add_u32 s48, s16, s98
    s_addc_u32 s49, s17, 0
    s_add_u32 s52, s20, s77
    s_addc_u32 s53, s21, 0
    s_mov_b32 s56, s28
    s_mov_b32 s57, s29
    s_add_u32 s60, s28, 0x100000
    s_addc_u32 s61, s29, 0
    s_add_u32 s36, s8, s71
    s_addc_u32 s37, s9, 0
    s_add_u32 s44, s12, s76
    s_addc_u32 s45, s13, 0
    s_load_dword s79, s[18:19], s82
    s_add_u32 s78, s101, 0x0
    s_and_b32 s78, s78, 0x7fff
    buffer_load_dwordx4 v[128:131], v2, s[32:35], s78 offen nt
    v_and_b32 v56, 15, v1
    v_lshlrev_b32 v56, 4, v56
    s_lshl_b32 s74, s73, 8
    s_add_u32 s75, s74, s72
    s_add_u32 s76, s74, s80
    s_add_u32 s76, s76, 0x100000
    s_lshl_b32 s83, s68, 7
    s_add_u32 s83, s83, 0xd0000
    s_add_u32 s77, s72, 2048
    s_cmp_eq_u32 s73, 0
    s_cselect_b32 s77, s77, 0x7fff0000
    s_cmp_eq_u32 s73, 1
    s_cselect_b32 s77, s83, s77
    v_mov_b32 v7, 0x7fff0000
    v_mov_b32 v57, s77
    v_add_u32 v58, s76, v56
    v_add_u32 v56, s75, v56
    v_cmp_eq_u32 vcc, 32, v1
    s_nop 1
    v_cndmask_b32 v7, v7, v57, vcc
    v_cmp_gt_u32 vcc, 32, v1
    s_nop 1
    v_cndmask_b32 v7, v7, v58, vcc
    v_cmp_gt_u32 vcc, 16, v1
    s_nop 1
    v_cndmask_b32 v7, v7, v56, vcc
    v_mov_b32 v60, -1
    v_mov_b32 v61, -1
    v_mov_b32 v62, -1
    v_mov_b32 v63, -1
    s_lshl_b32 s96, s66, 3
    s_add_u32 s96, s96, s73
    s_lshl_b32 s96, s96, 10
    s_add_u32 s96, s96, 0x90000
    s_lshl_b32 s97, s66, 13
    s_lshl_b32 s74, s67, 3
    s_add_u32 s74, s74, s73
    s_lshl_b32 s74, s74, 2
    s_add_u32 s97, s97, s74
    s_add_u32 s97, s97, 0x90200
    v_and_b32 v56, 15, v0
    v_and_b32 v57, 1, v0
    v_lshrrev_b32 v56, 1, v56
    v_mov_b32 v58, 0xffff
    v_mov_b32 v59, 0xffff0000
    v_cmp_eq_u32 vcc, 1, v57
    s_nop 1
    v_cndmask_b32 v58, v58, v59, vcc
    v_cmp_eq_u32 vcc, 0, v56
    s_nop 1
    v_cndmask_b32 v8, 0, v58, vcc
    v_cmp_eq_u32 vcc, 1, v56
    s_nop 1
    v_cndmask_b32 v9, 0, v58, vcc
    v_cmp_eq_u32 vcc, 2, v56
    s_nop 1
    v_cndmask_b32 v10, 0, v58, vcc
    v_cmp_eq_u32 vcc, 3, v56
    s_nop 1
    v_cndmask_b32 v11, 0, v58, vcc
    s_mov_b32 s78, 0x0
    buffer_load_dwordx4 v[32:35], v3, s[40:43], s78 offen
    s_add_u32 s78, s101, 0x400
    s_and_b32 s78, s78, 0x7fff
    buffer_load_dwordx4 v[132:135], v2, s[32:35], s78 offen nt
    s_mov_b32 s78, 0x2000
    buffer_load_dwordx4 v[36:39], v3, s[40:43], s78 offen
    s_add_u32 s78, s101, 0x800
    s_and_b32 s78, s78, 0x7fff
    buffer_load_dwordx4 v[136:139], v2, s[32:35], s78 offen nt
    buffer_load_dwordx4 v[48:51], v5, s[48:51], 0 offen
    s_add_u32 s78, s101, 0xc00
    s_and_b32 s78, s78, 0x7fff
    buffer_load_dwordx4 v[140:143], v2, s[32:35], s78 offen nt
    buffer_store_dwordx4 v[60:63], v7, s[56:59], 0 offen sc1
    s_waitcnt vmcnt(7)
    s_add_u32 s78, s101, 0x1000
    s_and_b32 s78, s78, 0x7fff
    buffer_load_dwordx4 v[144:147], v2, s[32:35], s78 offen nt
    v_lshlrev_b32 v232, 16, v224
    v_and_b32 v233, 0xffff0000, v224
    v_lshlrev_b32 v234, 16, v225
    v_and_b32 v235, 0xffff0000, v225
    v_lshlrev_b32 v236, 16, v226
    v_and_b32 v237, 0xffff0000, v226
    v_lshlrev_b32 v238, 16, v227
    v_and_b32 v239, 0xffff0000, v227
    v_add_f32 v240, v232, v233
    v_add_f32 v241, v234, v235
    v_add_f32 v242, v236, v237
    v_add_f32 v243, v238, v239
    v_add_f32 v240, v240, v241
    v_add_f32 v242, v242, v243
    v_add_f32 v240, v240, v242
    s_nop 1
    v_add_f32_dpp v240, v240, v240 row_ror:8 row_mask:0xf bank_mask:0xf
    s_nop 1
    v_add_f32_dpp v240, v240, v240 row_ror:4 row_mask:0xf bank_mask:0xf
    s_nop 1
    v_add_f32_dpp v240, v240, v240 row_ror:2 row_mask:0xf bank_mask:0xf
    s_nop 1
    v_add_f32_dpp v240, v240, v240 row_ror:1 row_mask:0xf bank_mask:0xf
    s_nop 1
    v_add_f32_dpp v240, v240, v240 row_bcast:15 row_mask:0xa bank_mask:0xf
    s_nop 1
    v_add_f32_dpp v240, v240, v240 row_bcast:31 row_mask:0xc bank_mask:0xf
    v_mul_f32 v240, 0x3b000000, v240
    s_nop 0
    v_readlane_b32 s74, v240, 63
    s_nop 1
    v_subrev_f32 v244, s74, v232
    v_subrev_f32 v245, s74, v233
    v_subrev_f32 v246, s74, v234
    v_subrev_f32 v247, s74, v235
    v_subrev_f32 v248, s74, v236
    v_subrev_f32 v249, s74, v237
    v_subrev_f32 v250, s74, v238
    v_subrev_f32 v251, s74, v239
    v_mul_f32 v240, v244, v244
    v_mul_f32 v241, v245, v245
    v_fma_f32 v240, v246, v246, v240
    v_fma_f32 v241, v247, v247, v241
    v_fma_f32 v240, v248, v248, v240
    v_fma_f32 v241, v249, v249, v241
    v_fma_f32 v240, v250, v250, v240
    v_fma_f32 v241, v251, v251, v241
    v_add_f32 v240, v240, v241
    s_nop 1
    v_add_f32_dpp v240, v240, v240 row_ror:8 row_mask:0xf bank_mask:0xf
    s_nop 1
    v_add_f32_dpp v240, v240, v240 row_ror:4 row_mask:0xf bank_mask:0xf
    s_nop 1
    v_add_f32_dpp v240, v240, v240 row_ror:2 row_mask:0xf bank_mask:0xf
    s_nop 1
    v_add_f32_dpp v240, v240, v240 row_ror:1 row_mask:0xf bank_mask:0xf
    s_nop 1
    v_add_f32_dpp v240, v240, v240 row_bcast:15 row_mask:0xa bank_mask:0xf
    s_nop 1
    v_add_f32_dpp v240, v240, v240 row_bcast:31 row_mask:0xc bank_mask:0xf
    v_mul_f32 v240, 0x3b000000, v240
    s_nop 0
    v_readlane_b32 s75, v240, 63
    v_cvt_pk_bf16_f32 v230, s74, s74
    v_lshlrev_b32 v230, 16, v230
    v_cvt_pk_bf16_f32 v231, s75, s75
    v_lshlrev_b32 v231, 16, v231
    v_add_f32 v231, 0x3727c5ac, v231
    v_cvt_pk_bf16_f32 v231, v231, v231
    v_lshlrev_b32 v231, 16, v231
    v_sqrt_f32 v231, v231
    s_nop 0
    v_cvt_pk_bf16_f32 v231, v231, v231
    v_lshlrev_b32 v231, 16, v231
    v_rcp_f32 v231, v231
    v_lshlrev_b32 v229, 16, v228
    v_sub_f32 v229, v229, v230
    v_cvt_pk_bf16_f32 v229, v229, v229
    v_lshlrev_b32 v229, 16, v229
    v_mul_f32 v229, v229, v231
    v_cvt_pk_bf16_f32 v46, v229, v229
    s_waitcnt vmcnt(6)
    s_add_u32 s78, s101, 0x1400
    s_and_b32 s78, s78, 0x7fff
    buffer_load_dwordx4 v[148:151], v2, s[32:35], s78 offen nt
    v_and_b32_dpp v16, v46, v8 row_newbcast:0 row_mask:0xf bank_mask:0xf
    v_and_b32_dpp v17, v46, v9 row_newbcast:0 row_mask:0xf bank_mask:0xf
    v_and_b32_dpp v18, v46, v10 row_newbcast:0 row_mask:0xf bank_mask:0xf
    v_and_b32_dpp v19, v46, v11 row_newbcast:0 row_mask:0xf bank_mask:0xf
    s_nop 1
    v_mfma_f32_16x16x32_bf16 v[24:27], v[32:35], v[16:19], 0
    s_waitcnt vmcnt(5)
    s_add_u32 s78, s101, 0x1800
    s_and_b32 s78, s78, 0x7fff
    buffer_load_dwordx4 v[152:155], v2, s[32:35], s78 offen nt
    v_and_b32_dpp v20, v46, v8 row_newbcast:8 row_mask:0xf bank_mask:0xf
    v_and_b32_dpp v21, v46, v9 row_newbcast:8 row_mask:0xf bank_mask:0xf
    v_and_b32_dpp v22, v46, v10 row_newbcast:8 row_mask:0xf bank_mask:0xf
    v_and_b32_dpp v23, v46, v11 row_newbcast:8 row_mask:0xf bank_mask:0xf
    s_nop 1
    v_mfma_f32_16x16x32_bf16 v[24:27], v[36:39], v[20:23], v[24:27]
    v_sub_f32 v232, v232, v230
    v_sub_f32 v233, v233, v230
    v_cvt_pk_bf16_f32 v240, v232, v233
    v_lshlrev_b32 v232, 16, v240
    v_and_b32 v233, 0xffff0000, v240
    v_mul_f32 v232, v232, v231
    v_mul_f32 v233, v233, v231
    v_cvt_pk_bf16_f32 v240, v232, v233
    v_lshlrev_b32 v232, 16, v240
    v_and_b32 v233, 0xffff0000, v240
    v_sub_f32 v234, v234, v230
    v_sub_f32 v235, v235, v230
    v_cvt_pk_bf16_f32 v240, v234, v235
    v_lshlrev_b32 v234, 16, v240
    v_and_b32 v235, 0xffff0000, v240
    v_mul_f32 v234, v234, v231
    v_mul_f32 v235, v235, v231
    v_cvt_pk_bf16_f32 v240, v234, v235
    v_lshlrev_b32 v234, 16, v240
    v_and_b32 v235, 0xffff0000, v240
    v_sub_f32 v236, v236, v230
    v_sub_f32 v237, v237, v230
    v_cvt_pk_bf16_f32 v240, v236, v237
    v_lshlrev_b32 v236, 16, v240
    v_and_b32 v237, 0xffff0000, v240
    v_mul_f32 v236, v236, v231
    v_mul_f32 v237, v237, v231
    v_cvt_pk_bf16_f32 v240, v236, v237
    v_lshlrev_b32 v236, 16, v240
    v_and_b32 v237, 0xffff0000, v240
    v_sub_f32 v238, v238, v230
    v_sub_f32 v239, v239, v230
    v_cvt_pk_bf16_f32 v240, v238, v239
    v_lshlrev_b32 v238, 16, v240
    v_and_b32 v239, 0xffff0000, v240
    v_mul_f32 v238, v238, v231
    v_mul_f32 v239, v239, v231
    v_cvt_pk_bf16_f32 v240, v238, v239
    v_lshlrev_b32 v238, 16, v240
    v_and_b32 v239, 0xffff0000, v240
    v_add_f32 v240, v232, v233
    v_add_f32 v241, v234, v235
    v_add_f32 v242, v236, v237
    v_add_f32 v243, v238, v239
    v_add_f32 v240, v240, v241
    v_add_f32 v242, v242, v243
    v_add_f32 v240, v240, v242
    s_nop 1
    v_add_f32_dpp v240, v240, v240 row_ror:8 row_mask:0xf bank_mask:0xf
    s_nop 1
    v_add_f32_dpp v240, v240, v240 row_ror:4 row_mask:0xf bank_mask:0xf
    s_nop 1
    v_add_f32_dpp v240, v240, v240 row_ror:2 row_mask:0xf bank_mask:0xf
    s_nop 1
    v_add_f32_dpp v240, v240, v240 row_ror:1 row_mask:0xf bank_mask:0xf
    s_nop 1
    v_add_f32_dpp v240, v240, v240 row_bcast:15 row_mask:0xa bank_mask:0xf
    s_nop 1
    v_add_f32_dpp v240, v240, v240 row_bcast:31 row_mask:0xc bank_mask:0xf
    v_mul_f32 v240, 0x3b000000, v240
    s_nop 0
    v_readlane_b32 s74, v240, 63
    s_nop 1
    v_subrev_f32 v244, s74, v232
    v_subrev_f32 v245, s74, v233
    v_subrev_f32 v246, s74, v234
    v_subrev_f32 v247, s74, v235
    v_subrev_f32 v248, s74, v236
    v_subrev_f32 v249, s74, v237
    v_subrev_f32 v250, s74, v238
    v_subrev_f32 v251, s74, v239
    v_mul_f32 v240, v244, v244
    v_mul_f32 v241, v245, v245
    v_fma_f32 v240, v246, v246, v240
    v_fma_f32 v241, v247, v247, v241
    v_fma_f32 v240, v248, v248, v240
    v_fma_f32 v241, v249, v249, v241
    v_fma_f32 v240, v250, v250, v240
    v_fma_f32 v241, v251, v251, v241
    v_add_f32 v240, v240, v241
    s_nop 1
    v_add_f32_dpp v240, v240, v240 row_ror:8 row_mask:0xf bank_mask:0xf
    s_nop 1
    v_add_f32_dpp v240, v240, v240 row_ror:4 row_mask:0xf bank_mask:0xf
    s_nop 1
    v_add_f32_dpp v240, v240, v240 row_ror:2 row_mask:0xf bank_mask:0xf
    s_nop 1
    v_add_f32_dpp v240, v240, v240 row_ror:1 row_mask:0xf bank_mask:0xf
    s_nop 1
    v_add_f32_dpp v240, v240, v240 row_bcast:15 row_mask:0xa bank_mask:0xf
    s_nop 1
    v_add_f32_dpp v240, v240, v240 row_bcast:31 row_mask:0xc bank_mask:0xf
    v_mul_f32 v240, 0x3b000000, v240
    s_nop 0
    v_readlane_b32 s75, v240, 63
    v_cvt_pk_bf16_f32 v230, s74, s74
    v_lshlrev_b32 v230, 16, v230
    v_cvt_pk_bf16_f32 v231, s75, s75
    v_lshlrev_b32 v231, 16, v231
    v_add_f32 v231, 0x3727c5ac, v231
    v_cvt_pk_bf16_f32 v231, v231, v231
    v_lshlrev_b32 v231, 16, v231
    v_sqrt_f32 v231, v231
    s_nop 0
    v_cvt_pk_bf16_f32 v231, v231, v231
    v_lshlrev_b32 v231, 16, v231
    v_rcp_f32 v231, v231
    v_lshlrev_b32 v229, 16, v46
    v_sub_f32 v229, v229, v230
    v_cvt_pk_bf16_f32 v229, v229, v229
    v_lshlrev_b32 v229, 16, v229
    v_mul_f32 v229, v229, v231
    v_cvt_pk_bf16_f32 v47, v229, v229
    v_lshlrev_b32 v47, 16, v47
    s_waitcnt vmcnt(4)
    s_add_u32 s78, s101, 0x1c00
    s_and_b32 s78, s78, 0x7fff
    buffer_load_dwordx4 v[156:159], v2, s[32:35], s78 offen nt
    v_lshlrev_b32 v232, 16, v48
    v_and_b32 v233, 0xffff0000, v48
    v_lshlrev_b32 v234, 16, v49
    v_and_b32 v235, 0xffff0000, v49
    v_lshlrev_b32 v236, 16, v50
    v_and_b32 v237, 0xffff0000, v50
    v_lshlrev_b32 v238, 16, v51
    v_and_b32 v239, 0xffff0000, v51
    v_mul_f32 v232, v232, v47
    v_mul_f32 v233, v233, v47
    v_mul_f32 v234, v234, v47
    v_mul_f32 v235, v235, v47
    v_mul_f32 v236, v236, v47
    v_mul_f32 v237, v237, v47
    v_mul_f32 v238, v238, v47
    v_mul_f32 v239, v239, v47
    v_permlane32_swap_b32 v232, v236
    v_permlane32_swap_b32 v233, v237
    v_permlane32_swap_b32 v234, v238
    v_permlane32_swap_b32 v235, v239
    v_add_f32 v232, v232, v236
    v_add_f32 v233, v233, v237
    v_add_f32 v234, v234, v238
    v_add_f32 v235, v235, v239
    s_nop 0
    v_permlane16_swap_b32 v232, v234
    v_permlane16_swap_b32 v233, v235
    v_add_f32 v232, v232, v234
    v_add_f32 v233, v233, v235
    s_nop 0
    v_add_f32_dpp v240, v232, v232 row_ror:8 row_mask:0xf bank_mask:0x3
    s_nop 1
    v_add_f32_dpp v240, v233, v233 row_ror:8 row_mask:0xf bank_mask:0xc
    v_and_b32 v241, 7, v1
    v_lshlrev_b32 v241, 5, v241
    v_lshrrev_b32 v242, 3, v1
    v_lshl_add_u32 v241, v242, 2, v241
    s_lshl_b32 s74, s73, 8
    v_add_u32 v241, s74, v241
    ds_write_b32 v241, v240 offset:4608
    v_lshrrev_b32 v56, 4, v1
    v_mul_u32_u24 v56, 144, v56
    v_and_b32 v57, 15, v1
    v_lshl_add_u32 v56, v57, 2, v56
    s_mul_i32 s74, s73, 576
    v_add_u32 v56, s74, v56
    s_mov_b32 exec_lo, 0x00ff00ff
    s_mov_b32 exec_hi, 0x00ff00ff
    ds_write_b32 v56, v24 offset:0
    ds_write_b32 v56, v25 offset:32
    ds_write_b32 v56, v26 offset:64
    ds_write_b32 v56, v27 offset:96
    s_mov_b64 exec, -1
    s_waitcnt vmcnt(3)
    s_add_u32 s78, s101, 0x2000
    s_and_b32 s78, s78, 0x7fff
    buffer_load_dwordx4 v[160:163], v2, s[32:35], s78 offen nt
    s_add_u32 s78, s101, 0x2400
    s_and_b32 s78, s78, 0x7fff
    buffer_load_dwordx4 v[164:167], v2, s[32:35], s78 offen nt
    s_waitcnt lgkmcnt(0)
    s_barrier
    s_cmp_eq_u32 s73, 0
    s_cbranch_scc0 L_nopub_1
    v_lshrrev_b32 v56, 3, v1
    v_mul_u32_u24 v56, 144, v56
    v_and_b32 v57, 7, v1
    v_lshl_add_u32 v56, v57, 4, v56
    v_lshlrev_b32 v58, 4, v1
    v_add_u32 v57, 4096, v58
    v_mov_b32 v59, 576
    v_mov_b32 v16, 256
    v_cmp_gt_u32 vcc, 32, v1
    s_nop 1
    v_cndmask_b32 v56, v57, v56, vcc
    v_cndmask_b32 v59, v16, v59, vcc
    s_mov_b32 exec_hi, 0xffff
    ds_read_b128 v[16:19], v56
    v_add_u32 v56, v56, v59
    ds_read_b128 v[20:23], v56
    v_add_u32 v56, v56, v59
    ds_read_b128 v[60:63], v56
    v_add_u32 v56, v56, v59
    ds_read_b128 v[40:43], v56
    v_add_u32 v56, v56, v59
    s_waitcnt lgkmcnt(0)
    v_add_f32 v16, v16, v20
    v_add_f32 v60, v60, v40
    v_add_f32 v17, v17, v21
    v_add_f32 v61, v61, v41
    v_add_f32 v18, v18, v22
    v_add_f32 v62, v62, v42
    v_add_f32 v19, v19, v23
    v_add_f32 v63, v63, v43
    v_add_f32 v16, v16, v60
    v_add_f32 v17, v17, v61
    v_add_f32 v18, v18, v62
    v_add_f32 v19, v19, v63
    v_mov_b32 v28, v16
    v_mov_b32 v29, v17
    v_mov_b32 v30, v18
    v_mov_b32 v31, v19
    ds_read_b128 v[16:19], v56
    v_add_u32 v56, v56, v59
    ds_read_b128 v[20:23], v56
    v_add_u32 v56, v56, v59
    ds_read_b128 v[60:63], v56
    v_add_u32 v56, v56, v59
    ds_read_b128 v[40:43], v56
    v_add_u32 v56, v56, v59
    s_waitcnt lgkmcnt(0)
    v_add_f32 v16, v16, v20
    v_add_f32 v60, v60, v40
    v_add_f32 v17, v17, v21
    v_add_f32 v61, v61, v41
    v_add_f32 v18, v18, v22
    v_add_f32 v62, v62, v42
    v_add_f32 v19, v19, v23
    v_add_f32 v63, v63, v43
    v_add_f32 v16, v16, v60
    v_add_f32 v17, v17, v61
    v_add_f32 v18, v18, v62
    v_add_f32 v19, v19, v63
    v_add_f32 v16, v16, v28
    v_add_f32 v17, v17, v29
    v_add_f32 v18, v18, v30
    v_add_f32 v19, v19, v31
    s_lshl_b32 s74, s68, 10
    s_add_u32 s74, s74, 0x90000
    buffer_store_dwordx4 v[16:19], v58, s[56:59], s74 offen sc1
    s_mov_b64 exec, -1
L_nopub_1:
    s_cmp_eq_u32 s73, 0
    s_cbranch_scc1 L_w0d_2
    s_waitcnt vmcnt(3)
L_w0d_2:
    s_add_u32 s78, s101, 0x2800
    s_and_b32 s78, s78, 0x7fff
    buffer_load_dwordx4 v[168:171], v2, s[32:35], s78 offen nt
    s_cmp_eq_u32 s73, 0
    s_cbranch_scc1 L_w0d_3
    s_waitcnt vmcnt(3)
L_w0d_3:
    s_add_u32 s78, s101, 0x2c00
    s_and_b32 s78, s78, 0x7fff
    buffer_load_dwordx4 v[172:175], v2, s[32:35], s78 offen nt
    s_cmp_eq_u32 s73, 0
    s_cbranch_scc1 L_w0d_4
    s_waitcnt vmcnt(3)
L_w0d_4:
    s_add_u32 s78, s101, 0x3000
    s_and_b32 s78, s78, 0x7fff
    buffer_load_dwordx4 v[176:179], v2, s[32:35], s78 offen nt
    s_cmp_eq_u32 s73, 0
    s_cbranch_scc1 L_w0d_5
    s_waitcnt vmcnt(3)
L_w0d_5:
    s_add_u32 s78, s101, 0x3400
    s_and_b32 s78, s78, 0x7fff
    buffer_load_dwordx4 v[180:183], v2, s[32:35], s78 offen nt
    s_cmp_eq_u32 s73, 0
    s_cbranch_scc1 L_w0d_6
    s_waitcnt vmcnt(3)
L_w0d_6:
    s_add_u32 s78, s101, 0x3800
    s_and_b32 s78, s78, 0x7fff
    buffer_load_dwordx4 v[184:187], v2, s[32:35], s78 offen nt
    s_cmp_eq_u32 s73, 0
    s_cbranch_scc1 L_w0d_7
    s_waitcnt vmcnt(3)
L_w0d_7:
    s_add_u32 s78, s101, 0x3c00
    s_and_b32 s78, s78, 0x7fff
    buffer_load_dwordx4 v[188:191], v2, s[32:35], s78 offen nt
    s_cmp_eq_u32 s73, 0
    s_cbranch_scc0 L_nocnt_8
    s_waitcnt vmcnt(6)
    s_lshl_b32 s74, s66, 3
    v_mov_b32 v56, s74
    v_mov_b32 v57, 1
    s_mov_b64 exec, 1
    global_atomic_add v45, v56, v57, s[26:27] sc0 sc1
    s_mov_b64 exec, -1
L_nocnt_8:
    s_cmp_eq_u32 s73, 0
    s_cbranch_scc1 L_w0d_9
    s_waitcnt vmcnt(3)
L_w0d_9:
    s_add_u32 s78, s101, 0x4000
    s_and_b32 s78, s78, 0x7fff
    buffer_load_dwordx4 v[192:195], v2, s[32:35], s78 offen nt
    s_cmp_eq_u32 s73, 0
    s_cbranch_scc1 L_w0d_10
    s_waitcnt vmcnt(3)
L_w0d_10:
    s_waitcnt vmcnt(11)
    s_add_u32 s78, s101, 0x4400
    s_and_b32 s78, s78, 0x7fff
    buffer_load_dwordx4 v[196:199], v2, s[32:35], s78 offen nt
    s_cmp_eq_u32 s73, 0
    s_cbranch_scc1 L_w0d_11
    s_waitcnt vmcnt(3)
L_w0d_11:
    s_waitcnt vmcnt(11)
    s_add_u32 s78, s101, 0x4800
    s_and_b32 s78, s78, 0x7fff
    buffer_load_dwordx4 v[200:203], v2, s[32:35], s78 offen nt
    s_cmp_eq_u32 s73, 0
    s_cbranch_scc1 L_w0d_12
    s_waitcnt vmcnt(3)
L_w0d_12:
    s_waitcnt vmcnt(11)
    s_add_u32 s78, s101, 0x4c00
    s_and_b32 s78, s78, 0x7fff
    buffer_load_dwordx4 v[204:207], v2, s[32:35], s78 offen nt
    s_cmp_eq_u32 s73, 0
    s_cbranch_scc1 L_w0d_13
    s_waitcnt vmcnt(3)
L_w0d_13:
    s_waitcnt vmcnt(11)
    s_add_u32 s78, s101, 0x5000
    s_and_b32 s78, s78, 0x7fff
    buffer_load_dwordx4 v[208:211], v2, s[32:35], s78 offen nt
    s_cmp_eq_u32 s73, 0
    s_cbranch_scc1 L_w0d_14
    s_waitcnt vmcnt(3)
L_w0d_14:
    s_waitcnt vmcnt(11)
    s_add_u32 s78, s101, 0x5400
    s_and_b32 s78, s78, 0x7fff
    buffer_load_dwordx4 v[212:215], v2, s[32:35], s78 offen nt
    s_cmp_eq_u32 s73, 0
    s_cbranch_scc0 L_nolast_15
    s_waitcnt vmcnt(6)
    v_readfirstlane_b32 s74, v45
    s_cmp_eq_u32 s74, 7
    s_cbranch_scc0 L_nolast_15
    s_lshl_b32 s74, s66, 10
    s_add_u32 s74, s74, 0xd0000
    v_lshlrev_b32 v56, 7, v1
    v_mov_b32 v57, 1
    s_mov_b64 exec, 0xff
    buffer_store_dword v57, v56, s[56:59], s74 offen sc1
    s_mov_b64 exec, -1
L_nolast_15:
    s_cmp_eq_u32 s73, 0
    s_cbranch_scc1 L_w0d_16
    s_waitcnt vmcnt(3)
L_w0d_16:
    s_waitcnt vmcnt(11)
    s_add_u32 s78, s101, 0x5800
    s_and_b32 s78, s78, 0x7fff
    buffer_load_dwordx4 v[216:219], v2, s[32:35], s78 offen nt
    s_cmp_eq_u32 s73, 0
    s_cbranch_scc1 L_w0d_17
    s_waitcnt vmcnt(3)
L_w0d_17:
    s_waitcnt vmcnt(11)
    s_add_u32 s78, s101, 0x5c00
    s_and_b32 s78, s78, 0x7fff
    buffer_load_dwordx4 v[220:223], v2, s[32:35], s78 offen nt
    s_cmp_eq_u32 s73, 0
    s_cbranch_scc1 L_w0d_18
    s_waitcnt vmcnt(3)
L_w0d_18:
    s_waitcnt vmcnt(11)
    s_add_u32 s78, s101, 0x6000
    s_and_b32 s78, s78, 0x7fff
    buffer_load_dwordx4 v[224:227], v2, s[32:35], s78 offen nt
    s_cmp_eq_u32 s73, 0
    s_cbranch_scc1 L_w0d_19
    s_waitcnt vmcnt(3)
L_w0d_19:
    s_waitcnt vmcnt(11)
    s_add_u32 s78, s101, 0x6400
    s_and_b32 s78, s78, 0x7fff
    buffer_load_dwordx4 v[228:231], v2, s[32:35], s78 offen nt
    s_cmp_eq_u32 s73, 0
    s_cbranch_scc1 L_w0d_20
    s_waitcnt vmcnt(3)
L_w0d_20:
    s_waitcnt vmcnt(11)
    s_add_u32 s78, s101, 0x6800
    s_and_b32 s78, s78, 0x7fff
    buffer_load_dwordx4 v[232:235], v2, s[32:35], s78 offen nt
    s_cmp_eq_u32 s73, 0
    s_cbranch_scc1 L_w0d_21
    s_waitcnt vmcnt(3)
L_w0d_21:
    s_waitcnt vmcnt(11)
    s_add_u32 s78, s101, 0x6c00
    s_and_b32 s78, s78, 0x7fff
    buffer_load_dwordx4 v[236:239], v2, s[32:35], s78 offen nt
    s_waitcnt vmcnt(3)
    s_add_u32 s78, s101, 0x7000
    s_and_b32 s78, s78, 0x7fff
    buffer_load_dwordx4 v[240:243], v2, s[32:35], s78 offen nt
    buffer_load_dword v44, off, s[56:59], s83 sc1
    s_waitcnt vmcnt(4)
    s_add_u32 s78, s101, 0x7400
    s_and_b32 s78, s78, 0x7fff
    buffer_load_dwordx4 v[244:247], v2, s[32:35], s78 offen nt
    s_waitcnt vmcnt(4)
    s_add_u32 s78, s101, 0x7800
    s_and_b32 s78, s78, 0x7fff
    buffer_load_dwordx4 v[248:251], v2, s[32:35], s78 offen nt
    s_waitcnt vmcnt(4)
    s_add_u32 s78, s101, 0x7c00
    s_and_b32 s78, s78, 0x7fff
    buffer_load_dwordx4 v[252:255], v2, s[32:35], s78 offen nt
    s_waitcnt vmcnt(4)
    s_add_u32 s78, s101, 0x0
    s_and_b32 s78, s78, 0x7fff
    buffer_load_dwordx4 v[64:67], v2, s[36:39], s78 offen nt
    s_waitcnt vmcnt(4)
    v_cmp_eq_u32 vcc, -1, v44
    s_cmp_eq_u64 vcc, 0
    s_cbranch_scc1 L_qok_22
    s_mov_b32 s82, 0
L_qlp_23:
    buffer_load_dword v44, off, s[56:59], s83 sc1
    s_waitcnt vmcnt(0)
    v_cmp_eq_u32 vcc, -1, v44
    s_cmp_eq_u64 vcc, 0
    s_cbranch_scc1 L_qok_22
    s_add_u32 s82, s82, 1
    s_cmp_lt_u32 s82, 0x8000
    s_cbranch_scc1 L_qlp_23
L_qok_22:
    v_lshlrev_b32 v45, 3, v1
    buffer_load_dwordx2 v[42:43], v45, s[56:59], s96 offen sc1
    v_and_b32 v41, 7, v1
    v_lshlrev_b32 v41, 10, v41
    buffer_load_dword v47, v41, s[56:59], s97 offen sc1
    v_lshlrev_b32 v41, 4, v0
    buffer_load_dwordx4 v[52:55], v41, s[52:55], 0 offen
    s_waitcnt vmcnt(6)
    s_add_u32 s78, s101, 0x400
    s_and_b32 s78, s78, 0x7fff
    buffer_load_dwordx4 v[68:71], v2, s[36:39], s78 offen nt
    s_waitcnt vmcnt(6)
    s_add_u32 s78, s101, 0x800
    s_and_b32 s78, s78, 0x7fff
    buffer_load_dwordx4 v[72:75], v2, s[36:39], s78 offen nt
    s_waitcnt vmcnt(6)
    s_add_u32 s78, s101, 0xc00
    s_and_b32 s78, s78, 0x7fff
    buffer_load_dwordx4 v[76:79], v2, s[36:39], s78 offen nt
    s_waitcnt vmcnt(6)
    s_add_u32 s78, s101, 0x1000
    s_and_b32 s78, s78, 0x7fff
    buffer_load_dwordx4 v[80:83], v2, s[36:39], s78 offen nt
    s_waitcnt vmcnt(3)
    s_add_u32 s78, s101, 0x1400
    s_and_b32 s78, s78, 0x7fff
    buffer_load_dwordx4 v[84:87], v2, s[36:39], s78 offen nt
    v_lshrrev_b32 v40, 4, v1
    v_mul_u32_u24 v40, 144, v40
    v_and_b32 v41, 15, v1
    v_lshl_add_u32 v40, v41, 3, v40
    s_mul_i32 s74, s73, 576
    v_add_u32 v40, s74, v40
    ds_write_b64 v40, v[42:43] offset:6656
    s_add_u32 s78, s101, 0x1800
    s_and_b32 s78, s78, 0x7fff
    buffer_load_dwordx4 v[88:91], v2, s[36:39], s78 offen nt
    s_waitcnt lgkmcnt(0)
    s_barrier
    v_lshrrev_b32 v40, 4, v1
    v_mul_u32_u24 v40, 1152, v40
    v_bfe_u32 v41, v1, 2, 2
    v_mul_u32_u24 v41, 144, v41
    v_and_b32 v42, 3, v1
    v_lshlrev_b32 v42, 5, v42
    v_add3_u32 v40, v40, v41, v42
    ds_read_b128 v[16:19], v40 offset:6656
    ds_read_b128 v[20:23], v40 offset:6672
    ds_read_b128 v[56:59], v40 offset:7232
    ds_read_b128 v[60:63], v40 offset:7248
    s_waitcnt lgkmcnt(0)
    v_add_f32 v16, v16, v56
    v_add_f32 v17, v17, v57
    v_add_f32 v18, v18, v58
    v_add_f32 v19, v19, v59
    v_add_f32 v20, v20, v60
    v_add_f32 v21, v21, v61
    v_add_f32 v22, v22, v62
    v_add_f32 v23, v23, v63
    v_permlane32_swap_b32 v16, v20
    v_permlane32_swap_b32 v17, v21
    v_permlane32_swap_b32 v18, v22
    v_permlane32_swap_b32 v19, v23
    v_add_f32 v16, v16, v20
    v_add_f32 v17, v17, v21
    v_add_f32 v18, v18, v22
    v_add_f32 v19, v19, v23
    s_nop 0
    v_permlane16_swap_b32 v16, v18
    v_permlane16_swap_b32 v17, v19
    v_add_f32 v16, v16, v18
    v_add_f32 v17, v17, v19
    v_cvt_pk_bf16_f32 v12, v16, v17
    v_mov_b32 v13, v12
    s_nop 1
    v_permlane16_swap_b32 v12, v13
    v_mov_b32 v14, v12
    v_mov_b32 v15, v13
    s_nop 0
    v_permlane32_swap_b32 v12, v14
    v_permlane32_swap_b32 v13, v15
    v_add_f32_dpp v47, v47, v47 row_half_mirror row_mask:0xf bank_mask:0xf
    s_nop 1
    v_add_f32_dpp v47, v47, v47 quad_perm:[2,3,0,1] row_mask:0xf bank_mask:0xf
    s_nop 1
    v_add_f32_dpp v47, v47, v47 quad_perm:[1,0,3,2] row_mask:0xf bank_mask:0xf
    v_cvt_pk_bf16_f32 v32, v47, v47
    v_lshlrev_b32 v32, 16, v32
    s_and_b32 s74, s73, 1
    s_lshl_b32 s74, s74, 4
    s_lshr_b32 s74, s79, s74
    s_lshl_b32 s74, s74, 16
    v_add_f32 v32, s74, v32
    v_cvt_pk_bf16_f32 v32, v32, v32
    v_lshlrev_b32 v32, 16, v32
    v_mul_f32 v33, v32, v32
    v_mov_b32 v34, 0xc0135761
    v_mov_b32 v35, 0xbdd2d3e8
    v_fma_f32 v33, v33, v35, v34
    v_mul_f32 v33, v33, v32
    v_exp_f32 v33, v33
    s_nop 0
    v_add_f32 v33, 1.0, v33
    v_rcp_f32 v33, v33
    s_nop 0
    v_mul_f32 v33, v32, v33
    v_cvt_pk_bf16_f32 v33, v33, v33
    v_lshlrev_b32 v33, 16, v33
    s_waitcnt vmcnt(3)
    s_add_u32 s78, s101, 0x1c00
    s_and_b32 s78, s78, 0x7fff
    buffer_load_dwordx4 v[92:95], v2, s[36:39], s78 offen nt
    v_lshlrev_b32 v36, 16, v52
    v_and_b32 v37, 0xffff0000, v52
    v_lshlrev_b32 v38, 16, v53
    v_and_b32 v39, 0xffff0000, v53
    v_lshlrev_b32 v40, 16, v54
    v_and_b32 v41, 0xffff0000, v54
    v_lshlrev_b32 v42, 16, v55
    v_and_b32 v43, 0xffff0000, v55
    v_mul_f32 v36, v36, v33
    v_mul_f32 v37, v37, v33
    v_mul_f32 v38, v38, v33
    v_mul_f32 v39, v39, v33
    v_mul_f32 v40, v40, v33
    v_mul_f32 v41, v41, v33
    v_mul_f32 v42, v42, v33
    v_mul_f32 v43, v43, v33
    v_lshlrev_b32 v34, 5, v0
    ds_write_b128 v34, v[36:39] offset:16640
    ds_write_b128 v34, v[40:43] offset:16656
    s_nop 1
    v_dot2_f32_bf16 v40, v128, v12, 0
    v_dot2_f32_bf16 v40, v129, v13, v40
    v_dot2_f32_bf16 v40, v130, v14, v40
    v_dot2_f32_bf16 v40, v131, v15, v40
    v_dot2_f32_bf16 v41, v132, v12, 0
    v_dot2_f32_bf16 v41, v133, v13, v41
    v_dot2_f32_bf16 v41, v134, v14, v41
    v_dot2_f32_bf16 v41, v135, v15, v41
    v_add_f32_dpp v44, v40, v40 row_ror:8 row_mask:0xf bank_mask:0x3
    s_nop 1
    v_add_f32_dpp v44, v41, v41 row_ror:8 row_mask:0xf bank_mask:0xc
    v_dot2_f32_bf16 v42, v136, v12, 0
    v_dot2_f32_bf16 v42, v137, v13, v42
    v_dot2_f32_bf16 v42, v138, v14, v42
    v_dot2_f32_bf16 v42, v139, v15, v42
    v_dot2_f32_bf16 v43, v140, v12, 0
    v_dot2_f32_bf16 v43, v141, v13, v43
    v_dot2_f32_bf16 v43, v142, v14, v43
    v_dot2_f32_bf16 v43, v143, v15, v43
    v_add_f32_dpp v45, v42, v42 row_ror:8 row_mask:0xf bank_mask:0x3
    s_nop 1
    v_add_f32_dpp v45, v43, v43 row_ror:8 row_mask:0xf bank_mask:0xc
    v_add_f32_dpp v32, v44, v44 row_half_mirror row_mask:0xf bank_mask:0x5
    s_nop 1
    v_add_f32_dpp v32, v45, v45 row_half_mirror row_mask:0xf bank_mask:0xa
    s_nop 1
    v_add_f32_dpp v32, v32, v32 quad_perm:[2,3,0,1] row_mask:0xf bank_mask:0xf
    s_nop 1
    v_add_f32_dpp v32, v32, v32 quad_perm:[1,0,3,2] row_mask:0xf bank_mask:0xf
    v_dot2_f32_bf16 v40, v144, v12, 0
    v_dot2_f32_bf16 v40, v145, v13, v40
    v_dot2_f32_bf16 v40, v146, v14, v40
    v_dot2_f32_bf16 v40, v147, v15, v40
    v_dot2_f32_bf16 v41, v148, v12, 0
    v_dot2_f32_bf16 v41, v149, v13, v41
    v_dot2_f32_bf16 v41, v150, v14, v41
    v_dot2_f32_bf16 v41, v151, v15, v41
    v_add_f32_dpp v44, v40, v40 row_ror:8 row_mask:0xf bank_mask:0x3
    s_nop 1
    v_add_f32_dpp v44, v41, v41 row_ror:8 row_mask:0xf bank_mask:0xc
    s_waitcnt vmcnt(3)
    s_add_u32 s78, s101, 0x2000
    s_and_b32 s78, s78, 0x7fff
    buffer_load_dwordx4 v[96:99], v2, s[36:39], s78 offen nt
    v_dot2_f32_bf16 v42, v152, v12, 0
    v_dot2_f32_bf16 v42, v153, v13, v42
    v_dot2_f32_bf16 v42, v154, v14, v42
    v_dot2_f32_bf16 v42, v155, v15, v42
    v_dot2_f32_bf16 v43, v156, v12, 0
    v_dot2_f32_bf16 v43, v157, v13, v43
    v_dot2_f32_bf16 v43, v158, v14, v43
    v_dot2_f32_bf16 v43, v159, v15, v43
    v_add_f32_dpp v45, v42, v42 row_ror:8 row_mask:0xf bank_mask:0x3
    s_nop 1
    v_add_f32_dpp v45, v43, v43 row_ror:8 row_mask:0xf bank_mask:0xc
    v_add_f32_dpp v33, v44, v44 row_half_mirror row_mask:0xf bank_mask:0x5
    s_nop 1
    v_add_f32_dpp v33, v45, v45 row_half_mirror row_mask:0xf bank_mask:0xa
    s_nop 1
    v_add_f32_dpp v33, v33, v33 quad_perm:[2,3,0,1] row_mask:0xf bank_mask:0xf
    s_nop 1
    v_add_f32_dpp v33, v33, v33 quad_perm:[1,0,3,2] row_mask:0xf bank_mask:0xf
    v_dot2_f32_bf16 v40, v160, v12, 0
    v_dot2_f32_bf16 v40, v161, v13, v40
    v_dot2_f32_bf16 v40, v162, v14, v40
    v_dot2_f32_bf16 v40, v163, v15, v40
    v_dot2_f32_bf16 v41, v164, v12, 0
    v_dot2_f32_bf16 v41, v165, v13, v41
    v_dot2_f32_bf16 v41, v166, v14, v41
    v_dot2_f32_bf16 v41, v167, v15, v41
    v_add_f32_dpp v44, v40, v40 row_ror:8 row_mask:0xf bank_mask:0x3
    s_nop 1
    v_add_f32_dpp v44, v41, v41 row_ror:8 row_mask:0xf bank_mask:0xc
    v_dot2_f32_bf16 v42, v168, v12, 0
    v_dot2_f32_bf16 v42, v169, v13, v42
    v_dot2_f32_bf16 v42, v170, v14, v42
    v_dot2_f32_bf16 v42, v171, v15, v42
    v_dot2_f32_bf16 v43, v172, v12, 0
    v_dot2_f32_bf16 v43, v173, v13, v43
    v_dot2_f32_bf16 v43, v174, v14, v43
    v_dot2_f32_bf16 v43, v175, v15, v43
    v_add_f32_dpp v45, v42, v42 row_ror:8 row_mask:0xf bank_mask:0x3
    s_nop 1
    v_add_f32_dpp v45, v43, v43 row_ror:8 row_mask:0xf bank_mask:0xc
    v_add_f32_dpp v34, v44, v44 row_half_mirror row_mask:0xf bank_mask:0x5
    s_nop 1
    v_add_f32_dpp v34, v45, v45 row_half_mirror row_mask:0xf bank_mask:0xa
    s_nop 1
    v_add_f32_dpp v34, v34, v34 quad_perm:[2,3,0,1] row_mask:0xf bank_mask:0xf
    s_nop 1
    v_add_f32_dpp v34, v34, v34 quad_perm:[1,0,3,2] row_mask:0xf bank_mask:0xf
    v_dot2_f32_bf16 v40, v176, v12, 0
    v_dot2_f32_bf16 v40, v177, v13, v40
    v_dot2_f32_bf16 v40, v178, v14, v40
    v_dot2_f32_bf16 v40, v179, v15, v40
    v_dot2_f32_bf16 v41, v180, v12, 0
    v_dot2_f32_bf16 v41, v181, v13, v41
    v_dot2_f32_bf16 v41, v182, v14, v41
    v_dot2_f32_bf16 v41, v183, v15, v41
    v_add_f32_dpp v44, v40, v40 row_ror:8 row_mask:0xf bank_mask:0x3
    s_nop 1
    v_add_f32_dpp v44, v41, v41 row_ror:8 row_mask:0xf bank_mask:0xc
    v_dot2_f32_bf16 v42, v184, v12, 0
    v_dot2_f32_bf16 v42, v185, v13, v42
    v_dot2_f32_bf16 v42, v186, v14, v42
    v_dot2_f32_bf16 v42, v187, v15, v42
    v_dot2_f32_bf16 v43, v188, v12, 0
    v_dot2_f32_bf16 v43, v189, v13, v43
    v_dot2_f32_bf16 v43, v190, v14, v43
    v_dot2_f32_bf16 v43, v191, v15, v43
    v_add_f32_dpp v45, v42, v42 row_ror:8 row_mask:0xf bank_mask:0x3
    s_nop 1
    v_add_f32_dpp v45, v43, v43 row_ror:8 row_mask:0xf bank_mask:0xc
    v_add_f32_dpp v35, v44, v44 row_half_mirror row_mask:0xf bank_mask:0x5
    s_nop 1
    v_add_f32_dpp v35, v45, v45 row_half_mirror row_mask:0xf bank_mask:0xa
    s_nop 1
    v_add_f32_dpp v35, v35, v35 quad_perm:[2,3,0,1] row_mask:0xf bank_mask:0xf
    s_nop 1
    v_add_f32_dpp v35, v35, v35 quad_perm:[1,0,3,2] row_mask:0xf bank_mask:0xf
    s_waitcnt vmcnt(3)
    s_add_u32 s78, s101, 0x2400
    s_and_b32 s78, s78, 0x7fff
    buffer_load_dwordx4 v[100:103], v2, s[36:39], s78 offen nt
    v_dot2_f32_bf16 v40, v192, v12, 0
    v_dot2_f32_bf16 v40, v193, v13, v40
    v_dot2_f32_bf16 v40, v194, v14, v40
    v_dot2_f32_bf16 v40, v195, v15, v40
    v_dot2_f32_bf16 v41, v196, v12, 0
    v_dot2_f32_bf16 v41, v197, v13, v41
    v_dot2_f32_bf16 v41, v198, v14, v41
    v_dot2_f32_bf16 v41, v199, v15, v41
    v_add_f32_dpp v44, v40, v40 row_ror:8 row_mask:0xf bank_mask:0x3
    s_nop 1
    v_add_f32_dpp v44, v41, v41 row_ror:8 row_mask:0xf bank_mask:0xc
    v_dot2_f32_bf16 v42, v200, v12, 0
    v_dot2_f32_bf16 v42, v201, v13, v42
    v_dot2_f32_bf16 v42, v202, v14, v42
    v_dot2_f32_bf16 v42, v203, v15, v42
    v_dot2_f32_bf16 v43, v204, v12, 0
    v_dot2_f32_bf16 v43, v205, v13, v43
    v_dot2_f32_bf16 v43, v206, v14, v43
    v_dot2_f32_bf16 v43, v207, v15, v43
    v_add_f32_dpp v45, v42, v42 row_ror:8 row_mask:0xf bank_mask:0x3
    s_nop 1
    v_add_f32_dpp v45, v43, v43 row_ror:8 row_mask:0xf bank_mask:0xc
    v_add_f32_dpp v36, v44, v44 row_half_mirror row_mask:0xf bank_mask:0x5
    s_nop 1
    v_add_f32_dpp v36, v45, v45 row_half_mirror row_mask:0xf bank_mask:0xa
    s_nop 1
    v_add_f32_dpp v36, v36, v36 quad_perm:[2,3,0,1] row_mask:0xf bank_mask:0xf
    s_nop 1
    v_add_f32_dpp v36, v36, v36 quad_perm:[1,0,3,2] row_mask:0xf bank_mask:0xf
    v_dot2_f32_bf16 v40, v208, v12, 0
    v_dot2_f32_bf16 v40, v209, v13, v40
    v_dot2_f32_bf16 v40, v210, v14, v40
    v_dot2_f32_bf16 v40, v211, v15, v40
    v_dot2_f32_bf16 v41, v212, v12, 0
    v_dot2_f32_bf16 v41, v213, v13, v41
    v_dot2_f32_bf16 v41, v214, v14, v41
    v_dot2_f32_bf16 v41, v215, v15, v41
    v_add_f32_dpp v44, v40, v40 row_ror:8 row_mask:0xf bank_mask:0x3
    s_nop 1
    v_add_f32_dpp v44, v41, v41 row_ror:8 row_mask:0xf bank_mask:0xc
    v_dot2_f32_bf16 v42, v216, v12, 0
    v_dot2_f32_bf16 v42, v217, v13, v42
    v_dot2_f32_bf16 v42, v218, v14, v42
    v_dot2_f32_bf16 v42, v219, v15, v42
    v_dot2_f32_bf16 v43, v220, v12, 0
    v_dot2_f32_bf16 v43, v221, v13, v43
    v_dot2_f32_bf16 v43, v222, v14, v43
    v_dot2_f32_bf16 v43, v223, v15, v43
    v_add_f32_dpp v45, v42, v42 row_ror:8 row_mask:0xf bank_mask:0x3
    s_nop 1
    v_add_f32_dpp v45, v43, v43 row_ror:8 row_mask:0xf bank_mask:0xc
    v_add_f32_dpp v37, v44, v44 row_half_mirror row_mask:0xf bank_mask:0x5
    s_nop 1
    v_add_f32_dpp v37, v45, v45 row_half_mirror row_mask:0xf bank_mask:0xa
    s_nop 1
    v_add_f32_dpp v37, v37, v37 quad_perm:[2,3,0,1] row_mask:0xf bank_mask:0xf
    s_nop 1
    v_add_f32_dpp v37, v37, v37 quad_perm:[1,0,3,2] row_mask:0xf bank_mask:0xf
    v_dot2_f32_bf16 v40, v224, v12, 0
    v_dot2_f32_bf16 v40, v225, v13, v40
    v_dot2_f32_bf16 v40, v226, v14, v40
    v_dot2_f32_bf16 v40, v227, v15, v40
    v_dot2_f32_bf16 v41, v228, v12, 0
    v_dot2_f32_bf16 v41, v229, v13, v41
    v_dot2_f32_bf16 v41, v230, v14, v41
    v_dot2_f32_bf16 v41, v231, v15, v41
    v_add_f32_dpp v44, v40, v40 row_ror:8 row_mask:0xf bank_mask:0x3
    s_nop 1
    v_add_f32_dpp v44, v41, v41 row_ror:8 row_mask:0xf bank_mask:0xc
    s_waitcnt vmcnt(3)
    s_setprio 0
    s_cmp_ge_u32 s73, 4
    s_cbranch_scc0 L_pr_24
    s_setprio 1
L_pr_24:
    s_add_u32 s78, s101, 0x2800
    s_and_b32 s78, s78, 0x7fff
    buffer_load_dwordx4 v[104:107], v2, s[36:39], s78 offen nt
    v_dot2_f32_bf16 v42, v232, v12, 0
    v_dot2_f32_bf16 v42, v233, v13, v42
    v_dot2_f32_bf16 v42, v234, v14, v42
    v_dot2_f32_bf16 v42, v235, v15, v42
    v_dot2_f32_bf16 v43, v236, v12, 0
    v_dot2_f32_bf16 v43, v237, v13, v43
    v_dot2_f32_bf16 v43, v238, v14, v43
    v_dot2_f32_bf16 v43, v239, v15, v43
    v_add_f32_dpp v45, v42, v42 row_ror:8 row_mask:0xf bank_mask:0x3
    s_nop 1
    v_add_f32_dpp v45, v43, v43 row_ror:8 row_mask:0xf bank_mask:0xc
    v_add_f32_dpp v38, v44, v44 row_half_mirror row_mask:0xf bank_mask:0x5
    s_nop 1
    v_add_f32_dpp v38, v45, v45 row_half_mirror row_mask:0xf bank_mask:0xa
    s_nop 1
    v_add_f32_dpp v38, v38, v38 quad_perm:[2,3,0,1] row_mask:0xf bank_mask:0xf
    s_nop 1
    v_add_f32_dpp v38, v38, v38 quad_perm:[1,0,3,2] row_mask:0xf bank_mask:0xf
    v_dot2_f32_bf16 v40, v240, v12, 0
    v_dot2_f32_bf16 v40, v241, v13, v40
    v_dot2_f32_bf16 v40, v242, v14, v40
    v_dot2_f32_bf16 v40, v243, v15, v40
    v_dot2_f32_bf16 v41, v244, v12, 0
    v_dot2_f32_bf16 v41, v245, v13, v41
    v_dot2_f32_bf16 v41, v246, v14, v41
    v_dot2_f32_bf16 v41, v247, v15, v41
    v_add_f32_dpp v44, v40, v40 row_ror:8 row_mask:0xf bank_mask:0x3
    s_nop 1
    v_add_f32_dpp v44, v41, v41 row_ror:8 row_mask:0xf bank_mask:0xc
    v_dot2_f32_bf16 v42, v248, v12, 0
    v_dot2_f32_bf16 v42, v249, v13, v42
    v_dot2_f32_bf16 v42, v250, v14, v42
    v_dot2_f32_bf16 v42, v251, v15, v42
    v_dot2_f32_bf16 v43, v252, v12, 0
    v_dot2_f32_bf16 v43, v253, v13, v43
    v_dot2_f32_bf16 v43, v254, v14, v43
    v_dot2_f32_bf16 v43, v255, v15, v43
    v_add_f32_dpp v45, v42, v42 row_ror:8 row_mask:0xf bank_mask:0x3
    s_nop 1
    v_add_f32_dpp v45, v43, v43 row_ror:8 row_mask:0xf bank_mask:0xc
    v_add_f32_dpp v39, v44, v44 row_half_mirror row_mask:0xf bank_mask:0x5
    s_nop 1
    v_add_f32_dpp v39, v45, v45 row_half_mirror row_mask:0xf bank_mask:0xa
    s_nop 1
    v_add_f32_dpp v39, v39, v39 quad_perm:[2,3,0,1] row_mask:0xf bank_mask:0xf
    s_nop 1
    v_add_f32_dpp v39, v39, v39 quad_perm:[1,0,3,2] row_mask:0xf bank_mask:0xf
    v_max3_f32 v56, v32, v33, v34
    v_max3_f32 v57, v35, v36, v37
    v_max_f32 v58, v38, v39
    v_max3_f32 v56, v56, v57, v58
    s_nop 1
    v_max_f32_dpp v56, v56, v56 row_ror:4 row_mask:0xf bank_mask:0xf
    s_nop 1
    v_max_f32_dpp v56, v56, v56 row_ror:8 row_mask:0xf bank_mask:0xf
    s_nop 1
    v_max_f32_dpp v56, v56, v56 row_bcast:15 row_mask:0xa bank_mask:0xf
    s_nop 1
    v_max_f32_dpp v56, v56, v56 row_bcast:31 row_mask:0xc bank_mask:0xf
    s_nop 0
    v_readlane_b32 s74, v56, 63
    v_mov_b32 v57, s81
    s_nop 0
    v_mul_f32 v44, s74, v57
    s_waitcnt vmcnt(3)
    s_add_u32 s78, s101, 0x2c00
    s_and_b32 s78, s78, 0x7fff
    buffer_load_dwordx4 v[108:111], v2, s[36:39], s78 offen nt
    v_fma_f32 v32, v32, v57, -v44
    v_fma_f32 v33, v33, v57, -v44
    v_fma_f32 v34, v34, v57, -v44
    v_fma_f32 v35, v35, v57, -v44
    v_fma_f32 v36, v36, v57, -v44
    v_fma_f32 v37, v37, v57, -v44
    v_fma_f32 v38, v38, v57, -v44
    v_fma_f32 v39, v39, v57, -v44
    v_exp_f32 v32, v32
    v_exp_f32 v33, v33
    v_exp_f32 v34, v34
    v_exp_f32 v35, v35
    v_exp_f32 v36, v36
    v_exp_f32 v37, v37
    v_exp_f32 v38, v38
    v_exp_f32 v39, v39
    v_add_f32 v58, v32, v33
    v_add_f32 v59, v34, v35
    v_add_f32 v60, v36, v37
    v_add_f32 v61, v38, v39
    v_add_f32 v58, v58, v59
    v_add_f32 v60, v60, v61
    v_add_f32 v45, v58, v60
    v_cvt_pk_bf16_f32 v32, v32, v32
    v_cvt_pk_bf16_f32 v33, v33, v33
    v_cvt_pk_bf16_f32 v34, v34, v34
    v_cvt_pk_bf16_f32 v35, v35, v35
    v_cvt_pk_bf16_f32 v36, v36, v36
    v_cvt_pk_bf16_f32 v37, v37, v37
    v_cvt_pk_bf16_f32 v38, v38, v38
    v_cvt_pk_bf16_f32 v39, v39, v39
    v_add_f32_dpp v45, v45, v45 row_ror:4 row_mask:0xf bank_mask:0xf
    s_nop 1
    v_add_f32_dpp v45, v45, v45 row_ror:8 row_mask:0xf bank_mask:0xf
    s_nop 1
    v_add_f32_dpp v45, v45, v45 row_bcast:15 row_mask:0xa bank_mask:0xf
    s_nop 1
    v_add_f32_dpp v45, v45, v45 row_bcast:31 row_mask:0xc bank_mask:0xf
    s_lshl_b32 s74, s73, 3
    v_mov_b32 v56, s74
    s_mov_b32 exec_lo, 0
    s_mov_b32 exec_hi, 0x80000000
    ds_write_b64 v56, v[44:45] offset:11264
    s_mov_b64 exec, -1
    s_add_u32 s78, s101, 0x3000
    s_and_b32 s78, s78, 0x7fff
    buffer_load_dwordx4 v[112:115], v2, s[36:39], s78 offen nt
    s_waitcnt lgkmcnt(0)
    s_barrier
    v_and_b32 v56, 7, v1
    v_lshlrev_b32 v56, 3, v56
    ds_read_b64 v[58:59], v56 offset:11264
    s_waitcnt lgkmcnt(0)
    v_mov_b32 v60, v58
    s_nop 1
    v_max_f32_dpp v60, v60, v60 row_half_mirror row_mask:0xf bank_mask:0xf
    s_nop 1
    v_max_f32_dpp v60, v60, v60 quad_perm:[2,3,0,1] row_mask:0xf bank_mask:0xf
    s_nop 1
    v_max_f32_dpp v60, v60, v60 quad_perm:[1,0,3,2] row_mask:0xf bank_mask:0xf
    v_sub_f32 v58, v58, v60
    v_exp_f32 v58, v58
    v_sub_f32 v46, v44, v60
    v_exp_f32 v46, v46
    v_mul_f32 v61, v58, v59
    s_nop 1
    v_add_f32_dpp v61, v61, v61 row_half_mirror row_mask:0xf bank_mask:0xf
    s_nop 1
    v_add_f32_dpp v61, v61, v61 quad_perm:[2,3,0,1] row_mask:0xf bank_mask:0xf
    s_nop 1
    v_add_f32_dpp v61, v61, v61 quad_perm:[1,0,3,2] row_mask:0xf bank_mask:0xf
    s_cmp_eq_u32 s73, 0
    s_cbranch_scc0 L_noml_25
    v_mov_b32 v56, s72
    s_mov_b64 exec, 1
    buffer_store_dwordx2 v[60:61], v56, s[56:59], 0 offen offset:2048 sc1
    s_mov_b64 exec, -1
L_noml_25:
    s_mov_b32 s78, 0x0
    buffer_load_dwordx4 v[192:195], v4, s[44:47], s78 offen offset:0
    ds_read_b32 v48, v6 offset:16640
    ds_read_b32 v49, v6 offset:18688
    ds_read_b32 v50, v6 offset:20736
    ds_read_b32 v51, v6 offset:22784
    ds_read_b32 v52, v6 offset:24832
    ds_read_b32 v53, v6 offset:26880
    ds_read_b32 v54, v6 offset:28928
    ds_read_b32 v55, v6 offset:30976
    v_add_u32 v7, s80, v6
    s_waitcnt lgkmcnt(0)
    v_add_f32 v48, v48, v49
    v_add_f32 v50, v50, v51
    v_add_f32 v52, v52, v53
    v_add_f32 v54, v54, v55
    v_add_f32 v48, v48, v50
    v_add_f32 v52, v52, v54
    v_add_f32 v48, v48, v52
    buffer_store_dword v48, v7, s[60:63], 0 offen sc1
    v_lshrrev_b32 v56, 4, v1
    v_and_b32 v57, 15, v1
    v_lshlrev_b32 v58, 7, v56
    v_lshl_add_u32 v58, v57, 4, v58
    s_mul_i32 s74, s73, 544
    v_add_u32 v40, s74, v58
    s_lshl_b32 s74, s73, 11
    v_add_u32 v42, s74, v58
    v_lshrrev_b32 v59, 2, v57
    v_mul_u32_u24 v59, 544, v59
    v_and_b32 v60, 1, v1
    v_lshl_add_u32 v59, v60, 6, v59
    v_lshl_add_u32 v59, v56, 4, v59
    v_bfe_u32 v60, v1, 1, 1
    v_lshl_add_u32 v59, v60, 2, v59
    s_lshr_b32 s74, s73, 1
    s_lshl_b32 s74, s74, 7
    s_and_b32 s75, s73, 1
    s_lshl_b32 s75, s75, 3
    s_add_u32 s74, s74, s75
    v_add_u32 v41, s74, v59
    v_and_b32 v59, 0x1e0, v0
    v_and_b32 v60, 7, v0
    v_lshl_add_u32 v59, v60, 2, v59
    v_bfe_u32 v60, v0, 3, 2
    v_add_u32 v59, v59, v60
    v_lshlrev_b32 v43, 2, v59
    s_waitcnt vmcnt(5)
    s_add_u32 s78, s101, 0x3400
    s_and_b32 s78, s78, 0x7fff
    buffer_load_dwordx4 v[116:119], v2, s[36:39], s78 offen nt
    s_mov_b32 s78, 0x0
    buffer_load_dwordx4 v[196:199], v4, s[44:47], s78 offen offset:256
    s_cmp_ge_u32 s2, 192
    s_cbranch_scc1 L_red
    s_waitcnt vmcnt(6)
    s_add_u32 s78, s101, 0x3800
    s_and_b32 s78, s78, 0x7fff
    buffer_load_dwordx4 v[120:123], v2, s[36:39], s78 offen nt
    v_and_b32_dpp v16, v32, v8 row_newbcast:0 row_mask:0xf bank_mask:0xf
    v_and_b32_dpp v17, v32, v9 row_newbcast:0 row_mask:0xf bank_mask:0xf
    v_and_b32_dpp v18, v32, v10 row_newbcast:0 row_mask:0xf bank_mask:0xf
    v_and_b32_dpp v19, v32, v11 row_newbcast:0 row_mask:0xf bank_mask:0xf
    s_nop 1
    v_mfma_f32_16x16x32_bf16 v[24:27], v[64:67], v[16:19], 0
    v_and_b32_dpp v20, v32, v8 row_newbcast:8 row_mask:0xf bank_mask:0xf
    v_and_b32_dpp v21, v32, v9 row_newbcast:8 row_mask:0xf bank_mask:0xf
    v_and_b32_dpp v22, v32, v10 row_newbcast:8 row_mask:0xf bank_mask:0xf
    v_and_b32_dpp v23, v32, v11 row_newbcast:8 row_mask:0xf bank_mask:0xf
    s_nop 1
    v_mfma_f32_16x16x32_bf16 v[28:31], v[68:71], v[20:23], 0
    v_and_b32_dpp v16, v32, v8 row_newbcast:4 row_mask:0xf bank_mask:0xf
    v_and_b32_dpp v17, v32, v9 row_newbcast:4 row_mask:0xf bank_mask:0xf
    v_and_b32_dpp v18, v32, v10 row_newbcast:4 row_mask:0xf bank_mask:0xf
    v_and_b32_dpp v19, v32, v11 row_newbcast:4 row_mask:0xf bank_mask:0xf
    s_nop 1
    v_mfma_f32_16x16x32_bf16 v[24:27], v[72:75], v[16:19], v[24:27]
    v_and_b32_dpp v20, v32, v8 row_newbcast:12 row_mask:0xf bank_mask:0xf
    v_and_b32_dpp v21, v32, v9 row_newbcast:12 row_mask:0xf bank_mask:0xf
    v_and_b32_dpp v22, v32, v10 row_newbcast:12 row_mask:0xf bank_mask:0xf
    v_and_b32_dpp v23, v32, v11 row_newbcast:12 row_mask:0xf bank_mask:0xf
    s_nop 1
    v_mfma_f32_16x16x32_bf16 v[28:31], v[76:79], v[20:23], v[28:31]
    v_and_b32_dpp v16, v33, v8 row_newbcast:0 row_mask:0xf bank_mask:0xf
    v_and_b32_dpp v17, v33, v9 row_newbcast:0 row_mask:0xf bank_mask:0xf
    v_and_b32_dpp v18, v33, v10 row_newbcast:0 row_mask:0xf bank_mask:0xf
    v_and_b32_dpp v19, v33, v11 row_newbcast:0 row_mask:0xf bank_mask:0xf
    s_nop 1
    v_mfma_f32_16x16x32_bf16 v[24:27], v[80:83], v[16:19], v[24:27]
    v_and_b32_dpp v20, v33, v8 row_newbcast:8 row_mask:0xf bank_mask:0xf
    v_and_b32_dpp v21, v33, v9 row_newbcast:8 row_mask:0xf bank_mask:0xf
    v_and_b32_dpp v22, v33, v10 row_newbcast:8 row_mask:0xf bank_mask:0xf
    v_and_b32_dpp v23, v33, v11 row_newbcast:8 row_mask:0xf bank_mask:0xf
    s_nop 1
    v_mfma_f32_16x16x32_bf16 v[28:31], v[84:87], v[20:23], v[28:31]
    v_and_b32_dpp v16, v33, v8 row_newbcast:4 row_mask:0xf bank_mask:0xf
    v_and_b32_dpp v17, v33, v9 row_newbcast:4 row_mask:0xf bank_mask:0xf
    v_and_b32_dpp v18, v33, v10 row_newbcast:4 row_mask:0xf bank_mask:0xf
    v_and_b32_dpp v19, v33, v11 row_newbcast:4 row_mask:0xf bank_mask:0xf
    s_nop 1
    v_mfma_f32_16x16x32_bf16 v[24:27], v[88:91], v[16:19], v[24:27]
    v_and_b32_dpp v20, v33, v8 row_newbcast:12 row_mask:0xf bank_mask:0xf
    v_and_b32_dpp v21, v33, v9 row_newbcast:12 row_mask:0xf bank_mask:0xf
    v_and_b32_dpp v22, v33, v10 row_newbcast:12 row_mask:0xf bank_mask:0xf
    v_and_b32_dpp v23, v33, v11 row_newbcast:12 row_mask:0xf bank_mask:0xf
    s_nop 1
    v_mfma_f32_16x16x32_bf16 v[28:31], v[92:95], v[20:23], v[28:31]
    v_and_b32_dpp v16, v34, v8 row_newbcast:0 row_mask:0xf bank_mask:0xf
    v_and_b32_dpp v17, v34, v9 row_newbcast:0 row_mask:0xf bank_mask:0xf
    v_and_b32_dpp v18, v34, v10 row_newbcast:0 row_mask:0xf bank_mask:0xf
    v_and_b32_dpp v19, v34, v11 row_newbcast:0 row_mask:0xf bank_mask:0xf
    s_nop 1
    v_mfma_f32_16x16x32_bf16 v[24:27], v[96:99], v[16:19], v[24:27]
    v_and_b32_dpp v20, v34, v8 row_newbcast:8 row_mask:0xf bank_mask:0xf
    v_and_b32_dpp v21, v34, v9 row_newbcast:8 row_mask:0xf bank_mask:0xf
    v_and_b32_dpp v22, v34, v10 row_newbcast:8 row_mask:0xf bank_mask:0xf
    v_and_b32_dpp v23, v34, v11 row_newbcast:8 row_mask:0xf bank_mask:0xf
    s_nop 1
    v_mfma_f32_16x16x32_bf16 v[28:31], v[100:103], v[20:23], v[28:31]
    v_and_b32_dpp v16, v34, v8 row_newbcast:4 row_mask:0xf bank_mask:0xf
    v_and_b32_dpp v17, v34, v9 row_newbcast:4 row_mask:0xf bank_mask:0xf
    v_and_b32_dpp v18, v34, v10 row_newbcast:4 row_mask:0xf bank_mask:0xf
    v_and_b32_dpp v19, v34, v11 row_newbcast:4 row_mask:0xf bank_mask:0xf
    s_nop 1
    v_mfma_f32_16x16x32_bf16 v[24:27], v[104:107], v[16:19], v[24:27]
    s_mov_b32 s78, 0x0
    buffer_load_dwordx4 v[200:203], v4, s[44:47], s78 offen offset:512
    s_waitcnt vmcnt(7)
    s_add_u32 s78, s101, 0x3c00
    s_and_b32 s78, s78, 0x7fff
    buffer_load_dwordx4 v[124:127], v2, s[36:39], s78 offen nt
    v_and_b32_dpp v20, v34, v8 row_newbcast:12 row_mask:0xf bank_mask:0xf
    v_and_b32_dpp v21, v34, v9 row_newbcast:12 row_mask:0xf bank_mask:0xf
    v_and_b32_dpp v22, v34, v10 row_newbcast:12 row_mask:0xf bank_mask:0xf
    v_and_b32_dpp v23, v34, v11 row_newbcast:12 row_mask:0xf bank_mask:0xf
    s_nop 1
    v_mfma_f32_16x16x32_bf16 v[28:31], v[108:111], v[20:23], v[28:31]
    s_mov_b32 s78, 0x0
    buffer_load_dwordx4 v[204:207], v4, s[44:47], s78 offen offset:768
    s_waitcnt vmcnt(8)
    s_add_u32 s78, s101, 0x4000
    s_and_b32 s78, s78, 0x7fff
    buffer_load_dwordx4 v[128:131], v2, s[36:39], s78 offen nt
    v_and_b32_dpp v16, v35, v8 row_newbcast:0 row_mask:0xf bank_mask:0xf
    v_and_b32_dpp v17, v35, v9 row_newbcast:0 row_mask:0xf bank_mask:0xf
    v_and_b32_dpp v18, v35, v10 row_newbcast:0 row_mask:0xf bank_mask:0xf
    v_and_b32_dpp v19, v35, v11 row_newbcast:0 row_mask:0xf bank_mask:0xf
    s_nop 1
    v_mfma_f32_16x16x32_bf16 v[24:27], v[112:115], v[16:19], v[24:27]
    s_waitcnt vmcnt(6)
    s_add_u32 s78, s101, 0x4400
    s_and_b32 s78, s78, 0x7fff
    buffer_load_dwordx4 v[132:135], v2, s[36:39], s78 offen nt
    v_and_b32_dpp v20, v35, v8 row_newbcast:8 row_mask:0xf bank_mask:0xf
    v_and_b32_dpp v21, v35, v9 row_newbcast:8 row_mask:0xf bank_mask:0xf
    v_and_b32_dpp v22, v35, v10 row_newbcast:8 row_mask:0xf bank_mask:0xf
    v_and_b32_dpp v23, v35, v11 row_newbcast:8 row_mask:0xf bank_mask:0xf
    s_nop 1
    v_mfma_f32_16x16x32_bf16 v[28:31], v[116:119], v[20:23], v[28:31]
    s_mov_b32 s78, 0x1000
    buffer_load_dwordx4 v[208:211], v4, s[44:47], s78 offen offset:0
    s_waitcnt vmcnt(6)
    s_add_u32 s78, s101, 0x4800
    s_and_b32 s78, s78, 0x7fff
    buffer_load_dwordx4 v[136:139], v2, s[36:39], s78 offen nt
    v_and_b32_dpp v16, v35, v8 row_newbcast:4 row_mask:0xf bank_mask:0xf
    v_and_b32_dpp v17, v35, v9 row_newbcast:4 row_mask:0xf bank_mask:0xf
    v_and_b32_dpp v18, v35, v10 row_newbcast:4 row_mask:0xf bank_mask:0xf
    v_and_b32_dpp v19, v35, v11 row_newbcast:4 row_mask:0xf bank_mask:0xf
    s_nop 1
    v_mfma_f32_16x16x32_bf16 v[24:27], v[120:123], v[16:19], v[24:27]
    s_mov_b32 s78, 0x1000
    buffer_load_dwordx4 v[212:215], v4, s[44:47], s78 offen offset:256
    s_waitcnt vmcnt(6)
    s_add_u32 s78, s101, 0x4c00
    s_and_b32 s78, s78, 0x7fff
    buffer_load_dwordx4 v[140:143], v2, s[36:39], s78 offen nt
    v_and_b32_dpp v20, v35, v8 row_newbcast:12 row_mask:0xf bank_mask:0xf
    v_and_b32_dpp v21, v35, v9 row_newbcast:12 row_mask:0xf bank_mask:0xf
    v_and_b32_dpp v22, v35, v10 row_newbcast:12 row_mask:0xf bank_mask:0xf
    v_and_b32_dpp v23, v35, v11 row_newbcast:12 row_mask:0xf bank_mask:0xf
    s_nop 1
    v_mfma_f32_16x16x32_bf16 v[28:31], v[124:127], v[20:23], v[28:31]
    s_mov_b32 s78, 0x1000
    buffer_load_dwordx4 v[216:219], v4, s[44:47], s78 offen offset:512
    s_waitcnt vmcnt(6)
    s_add_u32 s78, s101, 0x5000
    s_and_b32 s78, s78, 0x7fff
    buffer_load_dwordx4 v[144:147], v2, s[36:39], s78 offen nt
    v_and_b32_dpp v16, v36, v8 row_newbcast:0 row_mask:0xf bank_mask:0xf
    v_and_b32_dpp v17, v36, v9 row_newbcast:0 row_mask:0xf bank_mask:0xf
    v_and_b32_dpp v18, v36, v10 row_newbcast:0 row_mask:0xf bank_mask:0xf
    v_and_b32_dpp v19, v36, v11 row_newbcast:0 row_mask:0xf bank_mask:0xf
    s_nop 1
    v_mfma_f32_16x16x32_bf16 v[24:27], v[128:131], v[16:19], v[24:27]
    s_mov_b32 s78, 0x1000
    buffer_load_dwordx4 v[220:223], v4, s[44:47], s78 offen offset:768
    s_waitcnt vmcnt(7)
    s_add_u32 s78, s101, 0x5400
    s_and_b32 s78, s78, 0x7fff
    buffer_load_dwordx4 v[148:151], v2, s[36:39], s78 offen nt
    v_and_b32_dpp v20, v36, v8 row_newbcast:8 row_mask:0xf bank_mask:0xf
    v_and_b32_dpp v21, v36, v9 row_newbcast:8 row_mask:0xf bank_mask:0xf
    v_and_b32_dpp v22, v36, v10 row_newbcast:8 row_mask:0xf bank_mask:0xf
    v_and_b32_dpp v23, v36, v11 row_newbcast:8 row_mask:0xf bank_mask:0xf
    s_nop 1
    v_mfma_f32_16x16x32_bf16 v[28:31], v[132:135], v[20:23], v[28:31]
    s_waitcnt vmcnt(6)
    s_add_u32 s78, s101, 0x5800
    s_and_b32 s78, s78, 0x7fff
    buffer_load_dwordx4 v[152:155], v2, s[36:39], s78 offen nt
    v_and_b32_dpp v16, v36, v8 row_newbcast:4 row_mask:0xf bank_mask:0xf
    v_and_b32_dpp v17, v36, v9 row_newbcast:4 row_mask:0xf bank_mask:0xf
    v_and_b32_dpp v18, v36, v10 row_newbcast:4 row_mask:0xf bank_mask:0xf
    v_and_b32_dpp v19, v36, v11 row_newbcast:4 row_mask:0xf bank_mask:0xf
    s_nop 1
    v_mfma_f32_16x16x32_bf16 v[24:27], v[136:139], v[16:19], v[24:27]
    s_mov_b32 s78, 0x2000
    buffer_load_dwordx4 v[224:227], v4, s[44:47], s78 offen offset:0
    s_waitcnt vmcnt(6)
    s_add_u32 s78, s101, 0x5c00
    s_and_b32 s78, s78, 0x7fff
    buffer_load_dwordx4 v[156:159], v2, s[36:39], s78 offen nt
    v_and_b32_dpp v20, v36, v8 row_newbcast:12 row_mask:0xf bank_mask:0xf
    v_and_b32_dpp v21, v36, v9 row_newbcast:12 row_mask:0xf bank_mask:0xf
    v_and_b32_dpp v22, v36, v10 row_newbcast:12 row_mask:0xf bank_mask:0xf
    v_and_b32_dpp v23, v36, v11 row_newbcast:12 row_mask:0xf bank_mask:0xf
    s_nop 1
    v_mfma_f32_16x16x32_bf16 v[28:31], v[140:143], v[20:23], v[28:31]
    s_mov_b32 s78, 0x2000
    buffer_load_dwordx4 v[228:231], v4, s[44:47], s78 offen offset:256
    s_waitcnt vmcnt(6)
    s_add_u32 s78, s101, 0x6000
    s_and_b32 s78, s78, 0x7fff
    buffer_load_dwordx4 v[160:163], v2, s[36:39], s78 offen nt
    v_and_b32_dpp v16, v37, v8 row_newbcast:0 row_mask:0xf bank_mask:0xf
    v_and_b32_dpp v17, v37, v9 row_newbcast:0 row_mask:0xf bank_mask:0xf
    v_and_b32_dpp v18, v37, v10 row_newbcast:0 row_mask:0xf bank_mask:0xf
    v_and_b32_dpp v19, v37, v11 row_newbcast:0 row_mask:0xf bank_mask:0xf
    s_nop 1
    v_mfma_f32_16x16x32_bf16 v[24:27], v[144:147], v[16:19], v[24:27]
    s_mov_b32 s78, 0x2000
    buffer_load_dwordx4 v[232:235], v4, s[44:47], s78 offen offset:512
    s_waitcnt vmcnt(6)
    s_setprio 0
    s_cmp_ge_u32 s73, 4
    s_cbranch_scc0 L_pr_26
    s_setprio 0
L_pr_26:
    s_add_u32 s78, s101, 0x6400
    s_and_b32 s78, s78, 0x7fff
    buffer_load_dwordx4 v[164:167], v2, s[36:39], s78 offen nt
    v_and_b32_dpp v20, v37, v8 row_newbcast:8 row_mask:0xf bank_mask:0xf
    v_and_b32_dpp v21, v37, v9 row_newbcast:8 row_mask:0xf bank_mask:0xf
    v_and_b32_dpp v22, v37, v10 row_newbcast:8 row_mask:0xf bank_mask:0xf
    v_and_b32_dpp v23, v37, v11 row_newbcast:8 row_mask:0xf bank_mask:0xf
    s_nop 1
    v_mfma_f32_16x16x32_bf16 v[28:31], v[148:151], v[20:23], v[28:31]
    s_mov_b32 s78, 0x2000
    buffer_load_dwordx4 v[236:239], v4, s[44:47], s78 offen offset:768
    s_waitcnt vmcnt(7)
    s_add_u32 s78, s101, 0x6800
    s_and_b32 s78, s78, 0x7fff
    buffer_load_dwordx4 v[168:171], v2, s[36:39], s78 offen nt
    v_and_b32_dpp v16, v37, v8 row_newbcast:4 row_mask:0xf bank_mask:0xf
    v_and_b32_dpp v17, v37, v9 row_newbcast:4 row_mask:0xf bank_mask:0xf
    v_and_b32_dpp v18, v37, v10 row_newbcast:4 row_mask:0xf bank_mask:0xf
    v_and_b32_dpp v19, v37, v11 row_newbcast:4 row_mask:0xf bank_mask:0xf
    s_nop 1
    v_mfma_f32_16x16x32_bf16 v[24:27], v[152:155], v[16:19], v[24:27]
    s_waitcnt vmcnt(6)
    s_add_u32 s78, s101, 0x6c00
    s_and_b32 s78, s78, 0x7fff
    buffer_load_dwordx4 v[172:175], v2, s[36:39], s78 offen nt
    v_and_b32_dpp v20, v37, v8 row_newbcast:12 row_mask:0xf bank_mask:0xf
    v_and_b32_dpp v21, v37, v9 row_newbcast:12 row_mask:0xf bank_mask:0xf
    v_and_b32_dpp v22, v37, v10 row_newbcast:12 row_mask:0xf bank_mask:0xf
    v_and_b32_dpp v23, v37, v11 row_newbcast:12 row_mask:0xf bank_mask:0xf
    s_nop 1
    v_mfma_f32_16x16x32_bf16 v[28:31], v[156:159], v[20:23], v[28:31]
    s_mov_b32 s78, 0x3000
    buffer_load_dwordx4 v[240:243], v4, s[44:47], s78 offen offset:0
    s_waitcnt vmcnt(6)
    s_add_u32 s78, s101, 0x7000
    s_and_b32 s78, s78, 0x7fff
    buffer_load_dwordx4 v[176:179], v2, s[36:39], s78 offen nt
    v_and_b32_dpp v16, v38, v8 row_newbcast:0 row_mask:0xf bank_mask:0xf
    v_and_b32_dpp v17, v38, v9 row_newbcast:0 row_mask:0xf bank_mask:0xf
    v_and_b32_dpp v18, v38, v10 row_newbcast:0 row_mask:0xf bank_mask:0xf
    v_and_b32_dpp v19, v38, v11 row_newbcast:0 row_mask:0xf bank_mask:0xf
    s_nop 1
    v_mfma_f32_16x16x32_bf16 v[24:27], v[160:163], v[16:19], v[24:27]
    s_mov_b32 s78, 0x3000
    buffer_load_dwordx4 v[244:247], v4, s[44:47], s78 offen offset:256
    s_waitcnt vmcnt(6)
    s_add_u32 s78, s101, 0x7400
    s_and_b32 s78, s78, 0x7fff
    buffer_load_dwordx4 v[180:183], v2, s[36:39], s78 offen nt
    v_and_b32_dpp v20, v38, v8 row_newbcast:8 row_mask:0xf bank_mask:0xf
    v_and_b32_dpp v21, v38, v9 row_newbcast:8 row_mask:0xf bank_mask:0xf
    v_and_b32_dpp v22, v38, v10 row_newbcast:8 row_mask:0xf bank_mask:0xf
    v_and_b32_dpp v23, v38, v11 row_newbcast:8 row_mask:0xf bank_mask:0xf
    s_nop 1
    v_mfma_f32_16x16x32_bf16 v[28:31], v[164:167], v[20:23], v[28:31]
    s_mov_b32 s78, 0x3000
    buffer_load_dwordx4 v[248:251], v4, s[44:47], s78 offen offset:512
    s_waitcnt vmcnt(6)
    s_add_u32 s78, s101, 0x7800
    s_and_b32 s78, s78, 0x7fff
    buffer_load_dwordx4 v[184:187], v2, s[36:39], s78 offen nt
    v_and_b32_dpp v16, v38, v8 row_newbcast:4 row_mask:0xf bank_mask:0xf
    v_and_b32_dpp v17, v38, v9 row_newbcast:4 row_mask:0xf bank_mask:0xf
    v_and_b32_dpp v18, v38, v10 row_newbcast:4 row_mask:0xf bank_mask:0xf
    v_and_b32_dpp v19, v38, v11 row_newbcast:4 row_mask:0xf bank_mask:0xf
    s_nop 1
    v_mfma_f32_16x16x32_bf16 v[24:27], v[168:171], v[16:19], v[24:27]
    s_mov_b32 s78, 0x3000
    buffer_load_dwordx4 v[252:255], v4, s[44:47], s78 offen offset:768
    s_waitcnt vmcnt(7)
    s_add_u32 s78, s101, 0x7c00
    s_and_b32 s78, s78, 0x7fff
    buffer_load_dwordx4 v[188:191], v2, s[36:39], s78 offen nt
    v_and_b32_dpp v20, v38, v8 row_newbcast:12 row_mask:0xf bank_mask:0xf
    v_and_b32_dpp v21, v38, v9 row_newbcast:12 row_mask:0xf bank_mask:0xf
    v_and_b32_dpp v22, v38, v10 row_newbcast:12 row_mask:0xf bank_mask:0xf
    v_and_b32_dpp v23, v38, v11 row_newbcast:12 row_mask:0xf bank_mask:0xf
    s_nop 1
    v_mfma_f32_16x16x32_bf16 v[28:31], v[172:175], v[20:23], v[28:31]
    s_waitcnt vmcnt(6)
    v_and_b32_dpp v16, v39, v8 row_newbcast:0 row_mask:0xf bank_mask:0xf
    v_and_b32_dpp v17, v39, v9 row_newbcast:0 row_mask:0xf bank_mask:0xf
    v_and_b32_dpp v18, v39, v10 row_newbcast:0 row_mask:0xf bank_mask:0xf
    v_and_b32_dpp v19, v39, v11 row_newbcast:0 row_mask:0xf bank_mask:0xf
    s_nop 1
    v_mfma_f32_16x16x32_bf16 v[24:27], v[176:179], v[16:19], v[24:27]
    s_waitcnt vmcnt(4)
    v_and_b32_dpp v20, v39, v8 row_newbcast:8 row_mask:0xf bank_mask:0xf
    v_and_b32_dpp v21, v39, v9 row_newbcast:8 row_mask:0xf bank_mask:0xf
    v_and_b32_dpp v22, v39, v10 row_newbcast:8 row_mask:0xf bank_mask:0xf
    v_and_b32_dpp v23, v39, v11 row_newbcast:8 row_mask:0xf bank_mask:0xf
    s_nop 1
    v_mfma_f32_16x16x32_bf16 v[28:31], v[180:183], v[20:23], v[28:31]
    s_waitcnt vmcnt(2)
    v_and_b32_dpp v16, v39, v8 row_newbcast:4 row_mask:0xf bank_mask:0xf
    v_and_b32_dpp v17, v39, v9 row_newbcast:4 row_mask:0xf bank_mask:0xf
    v_and_b32_dpp v18, v39, v10 row_newbcast:4 row_mask:0xf bank_mask:0xf
    v_and_b32_dpp v19, v39, v11 row_newbcast:4 row_mask:0xf bank_mask:0xf
    s_nop 1
    v_mfma_f32_16x16x32_bf16 v[24:27], v[184:187], v[16:19], v[24:27]
    s_waitcnt vmcnt(0)
    v_and_b32_dpp v20, v39, v8 row_newbcast:12 row_mask:0xf bank_mask:0xf
    v_and_b32_dpp v21, v39, v9 row_newbcast:12 row_mask:0xf bank_mask:0xf
    v_and_b32_dpp v22, v39, v10 row_newbcast:12 row_mask:0xf bank_mask:0xf
    v_and_b32_dpp v23, v39, v11 row_newbcast:12 row_mask:0xf bank_mask:0xf
    s_nop 1
    v_mfma_f32_16x16x32_bf16 v[28:31], v[188:191], v[20:23], v[28:31]
    s_nop 7
    v_add_f32 v24, v24, v28
    v_add_f32 v25, v25, v29
    v_add_f32 v26, v26, v30
    v_add_f32 v27, v27, v31
    v_mul_f32 v24, v24, v46
    v_mul_f32 v25, v25, v46
    v_mul_f32 v26, v26, v46
    v_mul_f32 v27, v27, v46
    s_mov_b32 exec_lo, 0x00ff00ff
    s_mov_b32 exec_hi, 0x00ff00ff
    ds_write_b128 v40, v[24:27] offset:12032
    s_mov_b64 exec, -1
    s_waitcnt lgkmcnt(0)
    s_barrier
    ds_read_b32 v56, v41 offset:12032
    ds_read_b32 v57, v41 offset:14208
    s_waitcnt lgkmcnt(0)
    v_add_f32 v56, v56, v57
    s_nop 1
    v_add_f32_dpp v56, v56, v56 row_ror:8 row_mask:0xf bank_mask:0xf
    s_nop 1
    v_add_f32_dpp v56, v56, v56 row_ror:4 row_mask:0xf bank_mask:0xf
    v_cvt_pk_bf16_f32 v47, v56, v56
    s_nop 1
    v_and_b32_dpp v16, v47, v8 row_newbcast:0 row_mask:0xf bank_mask:0xf
    v_and_b32_dpp v17, v47, v9 row_newbcast:0 row_mask:0xf bank_mask:0xf
    v_and_b32_dpp v18, v47, v10 row_newbcast:0 row_mask:0xf bank_mask:0xf
    v_and_b32_dpp v19, v47, v11 row_newbcast:0 row_mask:0xf bank_mask:0xf
    v_and_b32_dpp v20, v47, v8 row_newbcast:1 row_mask:0xf bank_mask:0xf
    v_and_b32_dpp v21, v47, v9 row_newbcast:1 row_mask:0xf bank_mask:0xf
    v_and_b32_dpp v22, v47, v10 row_newbcast:1 row_mask:0xf bank_mask:0xf
    v_and_b32_dpp v23, v47, v11 row_newbcast:1 row_mask:0xf bank_mask:0xf
    v_and_b32_dpp v56, v47, v8 row_newbcast:2 row_mask:0xf bank_mask:0xf
    v_and_b32_dpp v57, v47, v9 row_newbcast:2 row_mask:0xf bank_mask:0xf
    v_and_b32_dpp v58, v47, v10 row_newbcast:2 row_mask:0xf bank_mask:0xf
    v_and_b32_dpp v59, v47, v11 row_newbcast:2 row_mask:0xf bank_mask:0xf
    v_and_b32_dpp v60, v47, v8 row_newbcast:3 row_mask:0xf bank_mask:0xf
    v_and_b32_dpp v61, v47, v9 row_newbcast:3 row_mask:0xf bank_mask:0xf
    v_and_b32_dpp v62, v47, v10 row_newbcast:3 row_mask:0xf bank_mask:0xf
    v_and_b32_dpp v63, v47, v11 row_newbcast:3 row_mask:0xf bank_mask:0xf
    v_mfma_f32_16x16x32_bf16 v[24:27], v[192:195], v[16:19], 0
    v_mfma_f32_16x16x32_bf16 v[28:31], v[196:199], v[16:19], 0
    v_mfma_f32_16x16x32_bf16 v[32:35], v[200:203], v[16:19], 0
    v_mfma_f32_16x16x32_bf16 v[36:39], v[204:207], v[16:19], 0
    v_mfma_f32_16x16x32_bf16 v[24:27], v[208:211], v[20:23], v[24:27]
    v_mfma_f32_16x16x32_bf16 v[28:31], v[212:215], v[20:23], v[28:31]
    v_mfma_f32_16x16x32_bf16 v[32:35], v[216:219], v[20:23], v[32:35]
    v_mfma_f32_16x16x32_bf16 v[36:39], v[220:223], v[20:23], v[36:39]
    v_mfma_f32_16x16x32_bf16 v[24:27], v[224:227], v[56:59], v[24:27]
    v_mfma_f32_16x16x32_bf16 v[28:31], v[228:231], v[56:59], v[28:31]
    v_mfma_f32_16x16x32_bf16 v[32:35], v[232:235], v[56:59], v[32:35]
    v_mfma_f32_16x16x32_bf16 v[36:39], v[236:239], v[56:59], v[36:39]
    v_mfma_f32_16x16x32_bf16 v[24:27], v[240:243], v[60:63], v[24:27]
    v_mfma_f32_16x16x32_bf16 v[28:31], v[244:247], v[60:63], v[28:31]
    v_mfma_f32_16x16x32_bf16 v[32:35], v[248:251], v[60:63], v[32:35]
    v_mfma_f32_16x16x32_bf16 v[36:39], v[252:255], v[60:63], v[36:39]
    s_mov_b32 exec_lo, 0x00ff00ff
    s_mov_b32 exec_hi, 0x00ff00ff
    s_nop 2
    ds_write_b128 v42, v[24:27] offset:16640
    ds_write_b128 v42, v[28:31] offset:17152
    ds_write_b128 v42, v[32:35] offset:17664
    ds_write_b128 v42, v[36:39] offset:18176
    s_mov_b64 exec, -1
    s_waitcnt lgkmcnt(0)
    s_barrier
    ds_read_b32 v56, v43 offset:16640
    ds_read_b32 v57, v43 offset:18688
    ds_read_b32 v58, v43 offset:20736
    ds_read_b32 v59, v43 offset:22784
    ds_read_b32 v60, v43 offset:24832
    ds_read_b32 v61, v43 offset:26880
    ds_read_b32 v62, v43 offset:28928
    ds_read_b32 v63, v43 offset:30976
    v_add_u32 v7, s72, v6
    s_waitcnt lgkmcnt(0)
    v_add_f32 v56, v56, v57
    v_add_f32 v58, v58, v59
    v_add_f32 v60, v60, v61
    v_add_f32 v62, v62, v63
    v_add_f32 v56, v56, v58
    v_add_f32 v60, v60, v62
    v_add_f32 v56, v56, v60
    buffer_store_dword v56, v7, s[56:59], 0 offen sc1
    s_branch L_fin
L_red:
    s_waitcnt vmcnt(6)
    s_add_u32 s78, s101, 0x3800
    s_and_b32 s78, s78, 0x7fff
    buffer_load_dwordx4 v[120:123], v2, s[36:39], s78 offen nt
    v_lshrrev_b32 v56, 1, v0
    v_mul_u32_u24 v56, 2176, v56
    v_mov_b32 v13, v56
    v_and_b32 v57, 1, v0
    v_lshl_add_u32 v12, v57, 4, v56
    s_sub_u32 s98, s2, 192
    s_lshl_b32 s77, s98, 5
    v_and_b32 v55, 7, v1
    v_lshlrev_b32 v55, 1, v55
    s_lshl_b32 s74, s98, 4
    v_add_u32 v55, s74, v55
    v_lshlrev_b32 v57, 7, v57
    v_lshrrev_b32 v56, 4, v1
    v_lshl_add_u32 v57, v56, 5, v57
    s_lshl_b32 s74, s73, 2
    v_add_u32 v45, s74, v57
    v_and_b32_dpp v16, v32, v8 row_newbcast:0 row_mask:0xf bank_mask:0xf
    v_and_b32_dpp v17, v32, v9 row_newbcast:0 row_mask:0xf bank_mask:0xf
    v_and_b32_dpp v18, v32, v10 row_newbcast:0 row_mask:0xf bank_mask:0xf
    v_and_b32_dpp v19, v32, v11 row_newbcast:0 row_mask:0xf bank_mask:0xf
    s_nop 1
    v_mfma_f32_16x16x32_bf16 v[24:27], v[64:67], v[16:19], 0
    v_and_b32_dpp v20, v32, v8 row_newbcast:8 row_mask:0xf bank_mask:0xf
    v_and_b32_dpp v21, v32, v9 row_newbcast:8 row_mask:0xf bank_mask:0xf
    v_and_b32_dpp v22, v32, v10 row_newbcast:8 row_mask:0xf bank_mask:0xf
    v_and_b32_dpp v23, v32, v11 row_newbcast:8 row_mask:0xf bank_mask:0xf
    s_nop 1
    v_mfma_f32_16x16x32_bf16 v[28:31], v[68:71], v[20:23], 0
    v_and_b32_dpp v16, v32, v8 row_newbcast:4 row_mask:0xf bank_mask:0xf
    v_and_b32_dpp v17, v32, v9 row_newbcast:4 row_mask:0xf bank_mask:0xf
    v_and_b32_dpp v18, v32, v10 row_newbcast:4 row_mask:0xf bank_mask:0xf
    v_and_b32_dpp v19, v32, v11 row_newbcast:4 row_mask:0xf bank_mask:0xf
    s_nop 1
    v_mfma_f32_16x16x32_bf16 v[24:27], v[72:75], v[16:19], v[24:27]
    v_and_b32_dpp v20, v32, v8 row_newbcast:12 row_mask:0xf bank_mask:0xf
    v_and_b32_dpp v21, v32, v9 row_newbcast:12 row_mask:0xf bank_mask:0xf
    v_and_b32_dpp v22, v32, v10 row_newbcast:12 row_mask:0xf bank_mask:0xf
    v_and_b32_dpp v23, v32, v11 row_newbcast:12 row_mask:0xf bank_mask:0xf
    s_nop 1
    v_mfma_f32_16x16x32_bf16 v[28:31], v[76:79], v[20:23], v[28:31]
    v_and_b32_dpp v16, v33, v8 row_newbcast:0 row_mask:0xf bank_mask:0xf
    v_and_b32_dpp v17, v33, v9 row_newbcast:0 row_mask:0xf bank_mask:0xf
    v_and_b32_dpp v18, v33, v10 row_newbcast:0 row_mask:0xf bank_mask:0xf
    v_and_b32_dpp v19, v33, v11 row_newbcast:0 row_mask:0xf bank_mask:0xf
    s_nop 1
    v_mfma_f32_16x16x32_bf16 v[24:27], v[80:83], v[16:19], v[24:27]
    v_and_b32_dpp v20, v33, v8 row_newbcast:8 row_mask:0xf bank_mask:0xf
    v_and_b32_dpp v21, v33, v9 row_newbcast:8 row_mask:0xf bank_mask:0xf
    v_and_b32_dpp v22, v33, v10 row_newbcast:8 row_mask:0xf bank_mask:0xf
    v_and_b32_dpp v23, v33, v11 row_newbcast:8 row_mask:0xf bank_mask:0xf
    s_nop 1
    v_mfma_f32_16x16x32_bf16 v[28:31], v[84:87], v[20:23], v[28:31]
    v_and_b32_dpp v16, v33, v8 row_newbcast:4 row_mask:0xf bank_mask:0xf
    v_and_b32_dpp v17, v33, v9 row_newbcast:4 row_mask:0xf bank_mask:0xf
    v_and_b32_dpp v18, v33, v10 row_newbcast:4 row_mask:0xf bank_mask:0xf
    v_and_b32_dpp v19, v33, v11 row_newbcast:4 row_mask:0xf bank_mask:0xf
    s_nop 1
    v_mfma_f32_16x16x32_bf16 v[24:27], v[88:91], v[16:19], v[24:27]
    v_and_b32_dpp v20, v33, v8 row_newbcast:12 row_mask:0xf bank_mask:0xf
    v_and_b32_dpp v21, v33, v9 row_newbcast:12 row_mask:0xf bank_mask:0xf
    v_and_b32_dpp v22, v33, v10 row_newbcast:12 row_mask:0xf bank_mask:0xf
    v_and_b32_dpp v23, v33, v11 row_newbcast:12 row_mask:0xf bank_mask:0xf
    s_nop 1
    v_mfma_f32_16x16x32_bf16 v[28:31], v[92:95], v[20:23], v[28:31]
    v_and_b32_dpp v16, v34, v8 row_newbcast:0 row_mask:0xf bank_mask:0xf
    v_and_b32_dpp v17, v34, v9 row_newbcast:0 row_mask:0xf bank_mask:0xf
    v_and_b32_dpp v18, v34, v10 row_newbcast:0 row_mask:0xf bank_mask:0xf
    v_and_b32_dpp v19, v34, v11 row_newbcast:0 row_mask:0xf bank_mask:0xf
    s_nop 1
    v_mfma_f32_16x16x32_bf16 v[24:27], v[96:99], v[16:19], v[24:27]
    v_and_b32_dpp v20, v34, v8 row_newbcast:8 row_mask:0xf bank_mask:0xf
    v_and_b32_dpp v21, v34, v9 row_newbcast:8 row_mask:0xf bank_mask:0xf
    v_and_b32_dpp v22, v34, v10 row_newbcast:8 row_mask:0xf bank_mask:0xf
    v_and_b32_dpp v23, v34, v11 row_newbcast:8 row_mask:0xf bank_mask:0xf
    s_nop 1
    v_mfma_f32_16x16x32_bf16 v[28:31], v[100:103], v[20:23], v[28:31]
    v_and_b32_dpp v16, v34, v8 row_newbcast:4 row_mask:0xf bank_mask:0xf
    v_and_b32_dpp v17, v34, v9 row_newbcast:4 row_mask:0xf bank_mask:0xf
    v_and_b32_dpp v18, v34, v10 row_newbcast:4 row_mask:0xf bank_mask:0xf
    v_and_b32_dpp v19, v34, v11 row_newbcast:4 row_mask:0xf bank_mask:0xf
    s_nop 1
    v_mfma_f32_16x16x32_bf16 v[24:27], v[104:107], v[16:19], v[24:27]
    s_mov_b32 s78, 0x0
    buffer_load_dwordx4 v[200:203], v4, s[44:47], s78 offen offset:512
    v_and_b32 v7, 31, v1
    v_lshlrev_b32 v7, 3, v7
    global_load_dword v54, v7, s[26:27] sc1
    s_waitcnt vmcnt(8)
    s_add_u32 s78, s101, 0x3c00
    s_and_b32 s78, s78, 0x7fff
    buffer_load_dwordx4 v[124:127], v2, s[36:39], s78 offen nt
    v_and_b32_dpp v20, v34, v8 row_newbcast:12 row_mask:0xf bank_mask:0xf
    v_and_b32_dpp v21, v34, v9 row_newbcast:12 row_mask:0xf bank_mask:0xf
    v_and_b32_dpp v22, v34, v10 row_newbcast:12 row_mask:0xf bank_mask:0xf
    v_and_b32_dpp v23, v34, v11 row_newbcast:12 row_mask:0xf bank_mask:0xf
    s_nop 1
    v_mfma_f32_16x16x32_bf16 v[28:31], v[108:111], v[20:23], v[28:31]
    s_mov_b32 s78, 0x0
    buffer_load_dwordx4 v[204:207], v4, s[44:47], s78 offen offset:768
    s_waitcnt vmcnt(9)
    s_add_u32 s78, s101, 0x4000
    s_and_b32 s78, s78, 0x7fff
    buffer_load_dwordx4 v[128:131], v2, s[36:39], s78 offen nt
    v_and_b32_dpp v16, v35, v8 row_newbcast:0 row_mask:0xf bank_mask:0xf
    v_and_b32_dpp v17, v35, v9 row_newbcast:0 row_mask:0xf bank_mask:0xf
    v_and_b32_dpp v18, v35, v10 row_newbcast:0 row_mask:0xf bank_mask:0xf
    v_and_b32_dpp v19, v35, v11 row_newbcast:0 row_mask:0xf bank_mask:0xf
    s_nop 1
    v_mfma_f32_16x16x32_bf16 v[24:27], v[112:115], v[16:19], v[24:27]
    s_waitcnt vmcnt(7)
    s_add_u32 s78, s101, 0x4400
    s_and_b32 s78, s78, 0x7fff
    buffer_load_dwordx4 v[132:135], v2, s[36:39], s78 offen nt
    v_and_b32_dpp v20, v35, v8 row_newbcast:8 row_mask:0xf bank_mask:0xf
    v_and_b32_dpp v21, v35, v9 row_newbcast:8 row_mask:0xf bank_mask:0xf
    v_and_b32_dpp v22, v35, v10 row_newbcast:8 row_mask:0xf bank_mask:0xf
    v_and_b32_dpp v23, v35, v11 row_newbcast:8 row_mask:0xf bank_mask:0xf
    s_nop 1
    v_mfma_f32_16x16x32_bf16 v[28:31], v[116:119], v[20:23], v[28:31]
    s_mov_b32 s78, 0x1000
    buffer_load_dwordx4 v[208:211], v4, s[44:47], s78 offen offset:0
    s_waitcnt vmcnt(7)
    s_add_u32 s78, s101, 0x4800
    s_and_b32 s78, s78, 0x7fff
    buffer_load_dwordx4 v[136:139], v2, s[36:39], s78 offen nt
    v_and_b32_dpp v16, v35, v8 row_newbcast:4 row_mask:0xf bank_mask:0xf
    v_and_b32_dpp v17, v35, v9 row_newbcast:4 row_mask:0xf bank_mask:0xf
    v_and_b32_dpp v18, v35, v10 row_newbcast:4 row_mask:0xf bank_mask:0xf
    v_and_b32_dpp v19, v35, v11 row_newbcast:4 row_mask:0xf bank_mask:0xf
    s_nop 1
    v_mfma_f32_16x16x32_bf16 v[24:27], v[120:123], v[16:19], v[24:27]
    s_mov_b32 s78, 0x1000
    buffer_load_dwordx4 v[212:215], v4, s[44:47], s78 offen offset:256
    s_waitcnt vmcnt(6)
    s_add_u32 s78, s101, 0x4c00
    s_and_b32 s78, s78, 0x7fff
    buffer_load_dwordx4 v[140:143], v2, s[36:39], s78 offen nt
    v_cmp_gt_u32 vcc, 8, v54
    s_cmp_eq_u64 vcc, 0
    s_cbranch_scc1 L_cntok_1026
    s_mov_b32 s82, 0
L_cntlp_1027:
    global_load_dword v54, v7, s[26:27] sc1
    s_waitcnt vmcnt(0)
    v_cmp_gt_u32 vcc, 8, v54
    s_cmp_eq_u64 vcc, 0
    s_cbranch_scc1 L_cntok_1026
    s_add_u32 s82, s82, 1
    s_cmp_lt_u32 s82, 0x8000
    s_cbranch_scc1 L_cntlp_1027
L_cntok_1026:
    v_and_b32_dpp v20, v35, v8 row_newbcast:12 row_mask:0xf bank_mask:0xf
    v_and_b32_dpp v21, v35, v9 row_newbcast:12 row_mask:0xf bank_mask:0xf
    v_and_b32_dpp v22, v35, v10 row_newbcast:12 row_mask:0xf bank_mask:0xf
    v_and_b32_dpp v23, v35, v11 row_newbcast:12 row_mask:0xf bank_mask:0xf
    s_nop 1
    v_mfma_f32_16x16x32_bf16 v[28:31], v[124:127], v[20:23], v[28:31]
    s_mov_b32 s78, 0x1000
    buffer_load_dwordx4 v[216:219], v4, s[44:47], s78 offen offset:512
    s_waitcnt vmcnt(6)
    s_add_u32 s78, s101, 0x5000
    s_and_b32 s78, s78, 0x7fff
    buffer_load_dwordx4 v[144:147], v2, s[36:39], s78 offen nt
    v_and_b32_dpp v16, v36, v8 row_newbcast:0 row_mask:0xf bank_mask:0xf
    v_and_b32_dpp v17, v36, v9 row_newbcast:0 row_mask:0xf bank_mask:0xf
    v_and_b32_dpp v18, v36, v10 row_newbcast:0 row_mask:0xf bank_mask:0xf
    v_and_b32_dpp v19, v36, v11 row_newbcast:0 row_mask:0xf bank_mask:0xf
    s_nop 1
    v_mfma_f32_16x16x32_bf16 v[24:27], v[128:131], v[16:19], v[24:27]
    s_mov_b32 s78, 0x1000
    buffer_load_dwordx4 v[220:223], v4, s[44:47], s78 offen offset:768
    s_waitcnt vmcnt(7)
    s_add_u32 s78, s101, 0x5400
    s_and_b32 s78, s78, 0x7fff
    buffer_load_dwordx4 v[148:151], v2, s[36:39], s78 offen nt
    v_and_b32_dpp v20, v36, v8 row_newbcast:8 row_mask:0xf bank_mask:0xf
    v_and_b32_dpp v21, v36, v9 row_newbcast:8 row_mask:0xf bank_mask:0xf
    v_and_b32_dpp v22, v36, v10 row_newbcast:8 row_mask:0xf bank_mask:0xf
    v_and_b32_dpp v23, v36, v11 row_newbcast:8 row_mask:0xf bank_mask:0xf
    s_nop 1
    v_mfma_f32_16x16x32_bf16 v[28:31], v[132:135], v[20:23], v[28:31]
    buffer_load_dwordx2 v[52:53], v13, s[56:59], 0 offen offset:2048 sc1
    buffer_load_dwordx4 v[48:51], v12, s[60:63], s77 offen sc1
    global_load_ushort v14, v55, s[4:5]
    global_load_ushort v15, v55, s[22:23]
    s_waitcnt vmcnt(10)
    s_add_u32 s78, s101, 0x5800
    s_and_b32 s78, s78, 0x7fff
    buffer_load_dwordx4 v[152:155], v2, s[36:39], s78 offen nt
    v_and_b32_dpp v16, v36, v8 row_newbcast:4 row_mask:0xf bank_mask:0xf
    v_and_b32_dpp v17, v36, v9 row_newbcast:4 row_mask:0xf bank_mask:0xf
    v_and_b32_dpp v18, v36, v10 row_newbcast:4 row_mask:0xf bank_mask:0xf
    v_and_b32_dpp v19, v36, v11 row_newbcast:4 row_mask:0xf bank_mask:0xf
    s_nop 1
    v_mfma_f32_16x16x32_bf16 v[24:27], v[136:139], v[16:19], v[24:27]
    s_mov_b32 s78, 0x2000
    buffer_load_dwordx4 v[224:227], v4, s[44:47], s78 offen offset:0
    s_waitcnt vmcnt(10)
    s_add_u32 s78, s101, 0x5c00
    s_and_b32 s78, s78, 0x7fff
    buffer_load_dwordx4 v[156:159], v2, s[36:39], s78 offen nt
    v_and_b32_dpp v20, v36, v8 row_newbcast:12 row_mask:0xf bank_mask:0xf
    v_and_b32_dpp v21, v36, v9 row_newbcast:12 row_mask:0xf bank_mask:0xf
    v_and_b32_dpp v22, v36, v10 row_newbcast:12 row_mask:0xf bank_mask:0xf
    v_and_b32_dpp v23, v36, v11 row_newbcast:12 row_mask:0xf bank_mask:0xf
    s_nop 1
    v_mfma_f32_16x16x32_bf16 v[28:31], v[140:143], v[20:23], v[28:31]
    s_mov_b32 s78, 0x2000
    buffer_load_dwordx4 v[228:231], v4, s[44:47], s78 offen offset:256
    s_waitcnt vmcnt(10)
    s_add_u32 s78, s101, 0x6000
    s_and_b32 s78, s78, 0x7fff
    buffer_load_dwordx4 v[160:163], v2, s[36:39], s78 offen nt
    v_and_b32_dpp v16, v37, v8 row_newbcast:0 row_mask:0xf bank_mask:0xf
    v_and_b32_dpp v17, v37, v9 row_newbcast:0 row_mask:0xf bank_mask:0xf
    v_and_b32_dpp v18, v37, v10 row_newbcast:0 row_mask:0xf bank_mask:0xf
    v_and_b32_dpp v19, v37, v11 row_newbcast:0 row_mask:0xf bank_mask:0xf
    s_nop 1
    v_mfma_f32_16x16x32_bf16 v[24:27], v[144:147], v[16:19], v[24:27]
    s_mov_b32 s78, 0x2000
    buffer_load_dwordx4 v[232:235], v4, s[44:47], s78 offen offset:512
    s_waitcnt vmcnt(10)
    s_setprio 0
    s_cmp_ge_u32 s73, 4
    s_cbranch_scc0 L_pr_1028
    s_setprio 0
L_pr_1028:
    s_add_u32 s78, s101, 0x6400
    s_and_b32 s78, s78, 0x7fff
    buffer_load_dwordx4 v[164:167], v2, s[36:39], s78 offen nt
    v_and_b32_dpp v20, v37, v8 row_newbcast:8 row_mask:0xf bank_mask:0xf
    v_and_b32_dpp v21, v37, v9 row_newbcast:8 row_mask:0xf bank_mask:0xf
    v_and_b32_dpp v22, v37, v10 row_newbcast:8 row_mask:0xf bank_mask:0xf
    v_and_b32_dpp v23, v37, v11 row_newbcast:8 row_mask:0xf bank_mask:0xf
    s_nop 1
    v_mfma_f32_16x16x32_bf16 v[28:31], v[148:151], v[20:23], v[28:31]
    s_mov_b32 s78, 0x2000
    buffer_load_dwordx4 v[236:239], v4, s[44:47], s78 offen offset:768
    s_waitcnt vmcnt(7)
    s_add_u32 s78, s101, 0x6800
    s_and_b32 s78, s78, 0x7fff
    buffer_load_dwordx4 v[168:171], v2, s[36:39], s78 offen nt
    v_max3_u32 v56, v48, v49, v50
    v_max3_u32 v56, v56, v51, v52
    v_max_u32 v56, v56, v53
    v_cmp_eq_u32 vcc, -1, v56
    s_cmp_eq_u64 vcc, 0
    s_cbranch_scc1 L_ok_1029
    s_mov_b32 s82, 0
L_lp_1030:
    buffer_load_dwordx2 v[52:53], v13, s[56:59], 0 offen offset:2048 sc1
    buffer_load_dwordx4 v[48:51], v12, s[60:63], s77 offen sc1
    s_waitcnt vmcnt(0)
    v_max3_u32 v56, v48, v49, v50
    v_max3_u32 v56, v56, v51, v52
    v_max_u32 v56, v56, v53
    v_cmp_eq_u32 vcc, -1, v56
    s_cmp_eq_u64 vcc, 0
    s_cbranch_scc1 L_ok_1029
    s_add_u32 s82, s82, 1
    s_cmp_lt_u32 s82, 0x8000
    s_cbranch_scc1 L_lp_1030
L_ok_1029:
    v_mov_b32 v56, v52
    s_nop 1
    v_max_f32_dpp v56, v56, v56 row_ror:8 row_mask:0xf bank_mask:0xf
    s_nop 1
    v_max_f32_dpp v56, v56, v56 row_ror:4 row_mask:0xf bank_mask:0xf
    s_nop 1
    v_max_f32_dpp v56, v56, v56 row_ror:2 row_mask:0xf bank_mask:0xf
    v_sub_f32 v52, v52, v56
    v_exp_f32 v52, v52
    s_nop 0
    v_mul_f32 v57, v52, v53
    s_nop 1
    v_add_f32_dpp v57, v57, v57 row_ror:8 row_mask:0xf bank_mask:0xf
    s_nop 1
    v_add_f32_dpp v57, v57, v57 row_ror:4 row_mask:0xf bank_mask:0xf
    s_nop 1
    v_add_f32_dpp v57, v57, v57 row_ror:2 row_mask:0xf bank_mask:0xf
    v_rcp_f32 v57, v57
    s_nop 0
    v_mul_f32 v13, v52, v57
    v_permlane32_swap_b32 v48, v50
    v_permlane32_swap_b32 v49, v51
    v_add_f32 v48, v48, v50
    v_add_f32 v49, v49, v51
    s_nop 1
    v_permlane16_swap_b32 v48, v49
    v_add_f32 v48, v48, v49
    s_nop 1
    v_add_f32_dpp v48, v48, v48 row_ror:8 row_mask:0xf bank_mask:0xf
    s_nop 1
    v_add_f32_dpp v48, v48, v48 row_ror:4 row_mask:0xf bank_mask:0xf
    s_nop 1
    v_add_f32_dpp v48, v48, v48 row_ror:2 row_mask:0xf bank_mask:0xf
    s_mov_b32 exec_lo, 0x00030003
    s_mov_b32 exec_hi, 0x00030003
    ds_write_b32 v45, v48 offset:11328
    s_mov_b64 exec, -1
    s_nop 1
    v_and_b32_dpp v16, v37, v8 row_newbcast:4 row_mask:0xf bank_mask:0xf
    v_and_b32_dpp v17, v37, v9 row_newbcast:4 row_mask:0xf bank_mask:0xf
    v_and_b32_dpp v18, v37, v10 row_newbcast:4 row_mask:0xf bank_mask:0xf
    v_and_b32_dpp v19, v37, v11 row_newbcast:4 row_mask:0xf bank_mask:0xf
    s_nop 1
    v_mfma_f32_16x16x32_bf16 v[24:27], v[152:155], v[16:19], v[24:27]
    s_waitcnt vmcnt(6)
    s_add_u32 s78, s101, 0x6c00
    s_and_b32 s78, s78, 0x7fff
    buffer_load_dwordx4 v[172:175], v2, s[36:39], s78 offen nt
    v_and_b32_dpp v20, v37, v8 row_newbcast:12 row_mask:0xf bank_mask:0xf
    v_and_b32_dpp v21, v37, v9 row_newbcast:12 row_mask:0xf bank_mask:0xf
    v_and_b32_dpp v22, v37, v10 row_newbcast:12 row_mask:0xf bank_mask:0xf
    v_and_b32_dpp v23, v37, v11 row_newbcast:12 row_mask:0xf bank_mask:0xf
    s_nop 1
    v_mfma_f32_16x16x32_bf16 v[28:31], v[156:159], v[20:23], v[28:31]
    s_mov_b32 s78, 0x3000
    buffer_load_dwordx4 v[240:243], v4, s[44:47], s78 offen offset:0
    s_waitcnt vmcnt(6)
    s_add_u32 s78, s101, 0x7000
    s_and_b32 s78, s78, 0x7fff
    buffer_load_dwordx4 v[176:179], v2, s[36:39], s78 offen nt
    v_and_b32_dpp v16, v38, v8 row_newbcast:0 row_mask:0xf bank_mask:0xf
    v_and_b32_dpp v17, v38, v9 row_newbcast:0 row_mask:0xf bank_mask:0xf
    v_and_b32_dpp v18, v38, v10 row_newbcast:0 row_mask:0xf bank_mask:0xf
    v_and_b32_dpp v19, v38, v11 row_newbcast:0 row_mask:0xf bank_mask:0xf
    s_nop 1
    v_mfma_f32_16x16x32_bf16 v[24:27], v[160:163], v[16:19], v[24:27]
    s_mov_b32 s78, 0x3000
    buffer_load_dwordx4 v[244:247], v4, s[44:47], s78 offen offset:256
    s_waitcnt vmcnt(6)
    s_add_u32 s78, s101, 0x7400
    s_and_b32 s78, s78, 0x7fff
    buffer_load_dwordx4 v[180:183], v2, s[36:39], s78 offen nt
    v_and_b32_dpp v20, v38, v8 row_newbcast:8 row_mask:0xf bank_mask:0xf
    v_and_b32_dpp v21, v38, v9 row_newbcast:8 row_mask:0xf bank_mask:0xf
    v_and_b32_dpp v22, v38, v10 row_newbcast:8 row_mask:0xf bank_mask:0xf
    v_and_b32_dpp v23, v38, v11 row_newbcast:8 row_mask:0xf bank_mask:0xf
    s_nop 1
    v_mfma_f32_16x16x32_bf16 v[28:31], v[164:167], v[20:23], v[28:31]
    s_mov_b32 s78, 0x3000
    buffer_load_dwordx4 v[248:251], v4, s[44:47], s78 offen offset:512
    s_waitcnt vmcnt(6)
    s_add_u32 s78, s101, 0x7800
    s_and_b32 s78, s78, 0x7fff
    buffer_load_dwordx4 v[184:187], v2, s[36:39], s78 offen nt
    v_and_b32_dpp v16, v38, v8 row_newbcast:4 row_mask:0xf bank_mask:0xf
    v_and_b32_dpp v17, v38, v9 row_newbcast:4 row_mask:0xf bank_mask:0xf
    v_and_b32_dpp v18, v38, v10 row_newbcast:4 row_mask:0xf bank_mask:0xf
    v_and_b32_dpp v19, v38, v11 row_newbcast:4 row_mask:0xf bank_mask:0xf
    s_nop 1
    v_mfma_f32_16x16x32_bf16 v[24:27], v[168:171], v[16:19], v[24:27]
    s_mov_b32 s78, 0x3000
    buffer_load_dwordx4 v[252:255], v4, s[44:47], s78 offen offset:768
    s_waitcnt vmcnt(7)
    s_add_u32 s78, s101, 0x7c00
    s_and_b32 s78, s78, 0x7fff
    buffer_load_dwordx4 v[188:191], v2, s[36:39], s78 offen nt
    v_and_b32_dpp v20, v38, v8 row_newbcast:12 row_mask:0xf bank_mask:0xf
    v_and_b32_dpp v21, v38, v9 row_newbcast:12 row_mask:0xf bank_mask:0xf
    v_and_b32_dpp v22, v38, v10 row_newbcast:12 row_mask:0xf bank_mask:0xf
    v_and_b32_dpp v23, v38, v11 row_newbcast:12 row_mask:0xf bank_mask:0xf
    s_nop 1
    v_mfma_f32_16x16x32_bf16 v[28:31], v[172:175], v[20:23], v[28:31]
    s_waitcnt vmcnt(6)
    v_and_b32_dpp v16, v39, v8 row_newbcast:0 row_mask:0xf bank_mask:0xf
    v_and_b32_dpp v17, v39, v9 row_newbcast:0 row_mask:0xf bank_mask:0xf
    v_and_b32_dpp v18, v39, v10 row_newbcast:0 row_mask:0xf bank_mask:0xf
    v_and_b32_dpp v19, v39, v11 row_newbcast:0 row_mask:0xf bank_mask:0xf
    s_nop 1
    v_mfma_f32_16x16x32_bf16 v[24:27], v[176:179], v[16:19], v[24:27]
    s_waitcnt vmcnt(4)
    v_and_b32_dpp v20, v39, v8 row_newbcast:8 row_mask:0xf bank_mask:0xf
    v_and_b32_dpp v21, v39, v9 row_newbcast:8 row_mask:0xf bank_mask:0xf
    v_and_b32_dpp v22, v39, v10 row_newbcast:8 row_mask:0xf bank_mask:0xf
    v_and_b32_dpp v23, v39, v11 row_newbcast:8 row_mask:0xf bank_mask:0xf
    s_nop 1
    v_mfma_f32_16x16x32_bf16 v[28:31], v[180:183], v[20:23], v[28:31]
    s_waitcnt vmcnt(2)
    v_and_b32_dpp v16, v39, v8 row_newbcast:4 row_mask:0xf bank_mask:0xf
    v_and_b32_dpp v17, v39, v9 row_newbcast:4 row_mask:0xf bank_mask:0xf
    v_and_b32_dpp v18, v39, v10 row_newbcast:4 row_mask:0xf bank_mask:0xf
    v_and_b32_dpp v19, v39, v11 row_newbcast:4 row_mask:0xf bank_mask:0xf
    s_nop 1
    v_mfma_f32_16x16x32_bf16 v[24:27], v[184:187], v[16:19], v[24:27]
    s_waitcnt vmcnt(0)
    v_and_b32_dpp v20, v39, v8 row_newbcast:12 row_mask:0xf bank_mask:0xf
    v_and_b32_dpp v21, v39, v9 row_newbcast:12 row_mask:0xf bank_mask:0xf
    v_and_b32_dpp v22, v39, v10 row_newbcast:12 row_mask:0xf bank_mask:0xf
    v_and_b32_dpp v23, v39, v11 row_newbcast:12 row_mask:0xf bank_mask:0xf
    s_nop 1
    v_mfma_f32_16x16x32_bf16 v[28:31], v[188:191], v[20:23], v[28:31]
    s_nop 7
    v_add_f32 v24, v24, v28
    v_add_f32 v25, v25, v29
    v_add_f32 v26, v26, v30
    v_add_f32 v27, v27, v31
    v_mul_f32 v24, v24, v46
    v_mul_f32 v25, v25, v46
    v_mul_f32 v26, v26, v46
    v_mul_f32 v27, v27, v46
    s_mov_b32 exec_lo, 0x00ff00ff
    s_mov_b32 exec_hi, 0x00ff00ff
    ds_write_b128 v40, v[24:27] offset:12032
    s_mov_b64 exec, -1
    s_waitcnt lgkmcnt(0)
    s_barrier
    ds_read_b32 v56, v41 offset:12032
    ds_read_b32 v57, v41 offset:14208
    s_waitcnt lgkmcnt(0)
    v_add_f32 v56, v56, v57
    s_nop 1
    v_add_f32_dpp v56, v56, v56 row_ror:8 row_mask:0xf bank_mask:0xf
    s_nop 1
    v_add_f32_dpp v56, v56, v56 row_ror:4 row_mask:0xf bank_mask:0xf
    v_cvt_pk_bf16_f32 v47, v56, v56
    s_nop 1
    v_and_b32_dpp v16, v47, v8 row_newbcast:0 row_mask:0xf bank_mask:0xf
    v_and_b32_dpp v17, v47, v9 row_newbcast:0 row_mask:0xf bank_mask:0xf
    v_and_b32_dpp v18, v47, v10 row_newbcast:0 row_mask:0xf bank_mask:0xf
    v_and_b32_dpp v19, v47, v11 row_newbcast:0 row_mask:0xf bank_mask:0xf
    v_and_b32_dpp v20, v47, v8 row_newbcast:1 row_mask:0xf bank_mask:0xf
    v_and_b32_dpp v21, v47, v9 row_newbcast:1 row_mask:0xf bank_mask:0xf
    v_and_b32_dpp v22, v47, v10 row_newbcast:1 row_mask:0xf bank_mask:0xf
    v_and_b32_dpp v23, v47, v11 row_newbcast:1 row_mask:0xf bank_mask:0xf
    v_and_b32_dpp v56, v47, v8 row_newbcast:2 row_mask:0xf bank_mask:0xf
    v_and_b32_dpp v57, v47, v9 row_newbcast:2 row_mask:0xf bank_mask:0xf
    v_and_b32_dpp v58, v47, v10 row_newbcast:2 row_mask:0xf bank_mask:0xf
    v_and_b32_dpp v59, v47, v11 row_newbcast:2 row_mask:0xf bank_mask:0xf
    v_and_b32_dpp v60, v47, v8 row_newbcast:3 row_mask:0xf bank_mask:0xf
    v_and_b32_dpp v61, v47, v9 row_newbcast:3 row_mask:0xf bank_mask:0xf
    v_and_b32_dpp v62, v47, v10 row_newbcast:3 row_mask:0xf bank_mask:0xf
    v_and_b32_dpp v63, v47, v11 row_newbcast:3 row_mask:0xf bank_mask:0xf
    v_mfma_f32_16x16x32_bf16 v[24:27], v[192:195], v[16:19], 0
    v_mfma_f32_16x16x32_bf16 v[28:31], v[196:199], v[16:19], 0
    v_mfma_f32_16x16x32_bf16 v[32:35], v[200:203], v[16:19], 0
    v_mfma_f32_16x16x32_bf16 v[36:39], v[204:207], v[16:19], 0
    v_mfma_f32_16x16x32_bf16 v[24:27], v[208:211], v[20:23], v[24:27]
    v_mfma_f32_16x16x32_bf16 v[28:31], v[212:215], v[20:23], v[28:31]
    v_mfma_f32_16x16x32_bf16 v[32:35], v[216:219], v[20:23], v[32:35]
    v_mfma_f32_16x16x32_bf16 v[36:39], v[220:223], v[20:23], v[36:39]
    v_mfma_f32_16x16x32_bf16 v[24:27], v[224:227], v[56:59], v[24:27]
    v_mfma_f32_16x16x32_bf16 v[28:31], v[228:231], v[56:59], v[28:31]
    v_mfma_f32_16x16x32_bf16 v[32:35], v[232:235], v[56:59], v[32:35]
    v_mfma_f32_16x16x32_bf16 v[36:39], v[236:239], v[56:59], v[36:39]
    v_mfma_f32_16x16x32_bf16 v[24:27], v[240:243], v[60:63], v[24:27]
    v_mfma_f32_16x16x32_bf16 v[28:31], v[244:247], v[60:63], v[28:31]
    v_mfma_f32_16x16x32_bf16 v[32:35], v[248:251], v[60:63], v[32:35]
    v_mfma_f32_16x16x32_bf16 v[36:39], v[252:255], v[60:63], v[36:39]
    s_mov_b32 exec_lo, 0x00ff00ff
    s_mov_b32 exec_hi, 0x00ff00ff
    s_nop 2
    ds_write_b128 v42, v[24:27] offset:16640
    ds_write_b128 v42, v[28:31] offset:17152
    ds_write_b128 v42, v[32:35] offset:17664
    ds_write_b128 v42, v[36:39] offset:18176
    s_mov_b64 exec, -1
    s_waitcnt lgkmcnt(0)
    s_barrier
    ds_read_b32 v56, v43 offset:16640
    ds_read_b32 v57, v43 offset:18688
    ds_read_b32 v58, v43 offset:20736
    ds_read_b32 v59, v43 offset:22784
    ds_read_b32 v60, v43 offset:24832
    ds_read_b32 v61, v43 offset:26880
    ds_read_b32 v62, v43 offset:28928
    ds_read_b32 v63, v43 offset:30976
    v_add_u32 v7, s72, v6
    s_waitcnt lgkmcnt(0)
    v_add_f32 v56, v56, v57
    v_add_f32 v58, v58, v59
    v_add_f32 v60, v60, v61
    v_add_f32 v62, v62, v63
    v_add_f32 v56, v56, v58
    v_add_f32 v60, v60, v62
    v_add_f32 v56, v56, v60
    buffer_store_dword v56, v7, s[56:59], 0 offen sc1
    buffer_load_dwordx4 v[48:51], v12, s[56:59], s77 offen sc1
    v_and_b32 v56, 7, v1
    v_lshlrev_b32 v44, 5, v56
    ds_read_b128 v[24:27], v44 offset:11328
    ds_read_b128 v[28:31], v44 offset:11344
    s_waitcnt lgkmcnt(0)
    v_add_f32 v24, v24, v25
    v_add_f32 v26, v26, v27
    v_add_f32 v28, v28, v29
    v_add_f32 v30, v30, v31
    v_add_f32 v24, v24, v26
    v_add_f32 v28, v28, v30
    v_add_f32 v24, v24, v28
    v_cvt_pk_bf16_f32 v24, v24, v24
    v_lshlrev_b32 v24, 16, v24
    v_lshlrev_b32 v15, 16, v15
    v_add_f32 v24, v24, v15
    v_cvt_pk_bf16_f32 v24, v24, v24
    v_lshlrev_b32 v24, 16, v24
    v_mul_f32 v25, 0xbfb8aa3b, v24
    v_exp_f32 v25, v25
    s_nop 0
    v_add_f32 v25, 1.0, v25
    v_rcp_f32 v25, v25
    s_nop 0
    v_mul_f32 v25, v24, v25
    v_cvt_pk_bf16_f32 v15, v25, v25
    v_lshlrev_b32 v15, 16, v15
    v_lshlrev_b32 v14, 16, v14
    s_waitcnt vmcnt(0)
    v_max3_u32 v56, v48, v49, v50
    v_max_u32 v56, v56, v51
    v_cmp_eq_u32 vcc, -1, v56
    s_cmp_eq_u64 vcc, 0
    s_cbranch_scc1 L_ok_1031
    s_mov_b32 s82, 0
L_lp_1032:
    buffer_load_dwordx4 v[48:51], v12, s[56:59], s77 offen sc1
    s_waitcnt vmcnt(0)
    v_max3_u32 v56, v48, v49, v50
    v_max_u32 v56, v56, v51
    v_cmp_eq_u32 vcc, -1, v56
    s_cmp_eq_u64 vcc, 0
    s_cbranch_scc1 L_ok_1031
    s_add_u32 s82, s82, 1
    s_cmp_lt_u32 s82, 0x8000
    s_cbranch_scc1 L_lp_1032
L_ok_1031:
    v_mul_f32 v48, v48, v13
    v_mul_f32 v49, v49, v13
    v_mul_f32 v50, v50, v13
    v_mul_f32 v51, v51, v13
    s_nop 0
    v_permlane32_swap_b32 v48, v50
    v_permlane32_swap_b32 v49, v51
    v_add_f32 v48, v48, v50
    v_add_f32 v49, v49, v51
    s_nop 1
    v_permlane16_swap_b32 v48, v49
    v_add_f32 v48, v48, v49
    s_nop 1
    v_add_f32_dpp v48, v48, v48 row_ror:8 row_mask:0xf bank_mask:0xf
    s_nop 1
    v_add_f32_dpp v48, v48, v48 row_ror:4 row_mask:0xf bank_mask:0xf
    s_nop 1
    v_add_f32_dpp v48, v48, v48 row_ror:2 row_mask:0xf bank_mask:0xf
    s_mov_b32 exec_lo, 0x00030003
    s_mov_b32 exec_hi, 0x00030003
    ds_write_b32 v45, v48 offset:11584
    s_mov_b64 exec, -1
    s_waitcnt lgkmcnt(0)
    s_barrier
    s_cmp_eq_u32 s73, 0
    s_cbranch_scc0 L_fin
    ds_read_b128 v[24:27], v44 offset:11584
    ds_read_b128 v[28:31], v44 offset:11600
    s_waitcnt lgkmcnt(0)
    v_add_f32 v24, v24, v25
    v_add_f32 v26, v26, v27
    v_add_f32 v28, v28, v29
    v_add_f32 v30, v30, v31
    v_add_f32 v24, v24, v26
    v_add_f32 v28, v28, v30
    v_add_f32 v24, v24, v28
    v_cvt_pk_bf16_f32 v24, v24, v24
    v_lshlrev_b32 v24, 16, v24
    v_mul_f32 v24, v24, v15
    v_cvt_pk_bf16_f32 v24, v24, v24
    v_lshlrev_b32 v24, 16, v24
    v_add_f32 v24, v14, v24
    v_cvt_pk_bf16_f32 v24, v24, v24
    s_mov_b64 exec, 0xff
    global_store_short v55, v24, s[24:25]
    s_mov_b64 exec, -1
L_fin:
L_end:
    s_endpgm
.section .rodata,"a"
.p2align 6
.amdhsa_kernel recurrent_scan__gqa_block_cached__mixer_channel_mlp__decode_kernel
  .amdhsa_next_free_vgpr 256
  .amdhsa_next_free_sgpr 102
  .amdhsa_accum_offset 256
  .amdhsa_group_segment_fixed_size 0
  .amdhsa_kernarg_size 104
  .amdhsa_user_sgpr_count 2
  .amdhsa_user_sgpr_kernarg_segment_ptr 1
  .amdhsa_system_sgpr_workgroup_id_x 1
  .amdhsa_float_denorm_mode_32 3
.end_amdhsa_kernel
```
